```python
import torch

def _softmax(x, axis=-1):
    return torch.softmax(x, dim=axis)

def _gelu(x):
    return torch.nn.functional.gelu(x, approximate='tanh')

def _silu(x):
    return torch.nn.functional.silu(x)

def _sigmoid(x):
    return torch.sigmoid(x)

def _layernorm(x, axis=-1, eps=1e-05):
    m = x.mean(dim=axis, keepdim=True)
    v = x.var(dim=axis, keepdim=True, unbiased=False)
    return (x - m) / torch.sqrt(v + eps)

def _scatter_add(tgt, idx, src, axis=0):
    return tgt.clone().index_add_(axis, idx, src)

def _segment_sum(src, seg, n):
    out = torch.zeros((n,) + src.shape[1:], dtype=src.dtype)
    return out.index_add_(0, seg, src)

def _pad(x, pw):
    flat = tuple((v for pair in reversed(pw) for v in pair))
    return torch.nn.functional.pad(x, flat)
kernel_name = 'adaLN_cond__sliding_block_cached__swiglu_ffn__decode'

def setup_inputs():

    _w = lambda a: (lambda t: t.to(torch.bfloat16) if t.is_floating_point() else t)(torch.as_tensor(a))

    def _A_setup():
        B, Sq, D = (1, 1, 1024)
        Hq, Hkv, Sk, Dh = (32, 4, 65536, 128)
        assert Hq % Hkv == 0, (Hq, Hkv)
        return {'x': _w((lambda *s: torch.randn(*s, dtype=torch.bfloat16) * 0.1)(B, Sq, D)), 'k_cache': _w((lambda *s: torch.randn(*s, dtype=torch.bfloat16) * 0.8)(B, Hkv, Sk, Dh)), 'v_cache': _w((lambda *s: torch.randn(*s, dtype=torch.bfloat16) * 0.8)(B, Hkv, Sk, Dh)), 'wq': _w((lambda *s: torch.randn(*s, dtype=torch.bfloat16) * 0.8)(D, Hq * Dh) * D ** (-0.5)), 'wo': _w((lambda *s: torch.randn(*s, dtype=torch.bfloat16) * 0.8)(Hq * Dh, D) * (Hq * Dh) ** (-0.5))}
    _A_in = _A_setup()

    def _B_setup():
        B, S, D, F = (1, 1, 1024, 3584)
        return {'x': _w((lambda *s: torch.randn(*s, dtype=torch.bfloat16) * 0.1)(B, S, D)), 'w_gate': _w((lambda *s: torch.randn(*s, dtype=torch.bfloat16) * 0.1)(D, F)), 'w_up': _w((lambda *s: torch.randn(*s, dtype=torch.bfloat16) * 0.1)(D, F)), 'w_down': _w((lambda *s: torch.randn(*s, dtype=torch.bfloat16) * 0.1)(F, D))}
    _B_in = _B_setup()
    return {'A_x': _A_in['x'], 'A_k_cache': _A_in['k_cache'], 'A_v_cache': _A_in['v_cache'], 'A_wq': _A_in['wq'], 'A_wo': _A_in['wo'], 'B_x': _B_in['x'], 'B_w_gate': _B_in['w_gate'], 'B_w_up': _B_in['w_up'], 'B_w_down': _B_in['w_down'], 'c': _w((lambda *s: torch.randn(*s, dtype=torch.bfloat16) * 0.2)(1, 1024) * 8.0), 'w_mod': _w((lambda *s: torch.randn(*s, dtype=torch.bfloat16) * 0.2)(1024, 6 * 1024) * 1024 ** (-0.5) * 8.0)}

def reference(A_x, A_k_cache, A_v_cache, A_wq, A_wo, B_x, B_w_gate, B_w_up, B_w_down, c, w_mod):

    def _A_ref(x, k_cache, v_cache, wq, wo):
        B, Sq, D = x.shape
        Hq, Dh = (32, 128)
        Hkv, Sk = (k_cache.shape[1], k_cache.shape[2])
        W = min(4096, max(256, Sk // 4))
        rep = Hq // Hkv
        q = (lambda x, *d: x.permute(*d))((x @ wq).reshape(B, Sq, Hq, Dh), 0, 2, 1, 3)
        k = (lambda x, n, axis: torch.repeat_interleave(x, n, dim=axis))(k_cache[:, :, Sk - W:, :], rep, axis=1)
        v = (lambda x, n, axis: torch.repeat_interleave(x, n, dim=axis))(v_cache[:, :, Sk - W:, :], rep, axis=1)
        scores = torch.einsum('bhqd,bhkd->bhqk', q, k) * Dh ** (-0.5)
        p = _softmax(scores, axis=-1)
        o = torch.einsum('bhqk,bhkd->bhqd', p, v)
        return (lambda x, *d: x.permute(*d))(o, 0, 2, 1, 3).reshape(B, Sq, Hq * Dh) @ wo

    def _B_ref(x, w_gate, w_up, w_down):
        g = _silu(x @ w_gate)
        u = x @ w_up
        return g * u @ w_down
    x = A_x
    mod = (_silu(c) @ w_mod).reshape(c.shape[0], 6, 1, -1)
    sa, ca, ga, sb, cb, gb = (mod[:, 0].clone(), mod[:, 1].clone(), mod[:, 2].clone(), mod[:, 3].clone(), mod[:, 4].clone(), mod[:, 5].clone())
    h = _layernorm(x, axis=-1) * (1 + ca) + sa
    x = x + ga * _A_ref(h, A_k_cache, A_v_cache, A_wq, A_wo)
    h = _layernorm(x, axis=-1) * (1 + cb) + sb
    x = x + gb * _B_ref(h, B_w_gate, B_w_up, B_w_down)
    return x
```

```asm
; @launch grid=(256,1,1) block=(512,1,1) lds=157696
.amdgcn_target "amdgcn-amd-amdhsa--gfx950"
.text
.globl adaLN_cond__sliding_block_cached__swiglu_ffn__decode_kernel
.p2align 8
.type adaLN_cond__sliding_block_cached__swiglu_ffn__decode_kernel,@function
adaLN_cond__sliding_block_cached__swiglu_ffn__decode_kernel:
    s_cmp_ge_u32 s2, 256
    s_cbranch_scc1 L_end
    s_load_dwordx16 s[16:31], s[0:1], 0
    s_load_dwordx8 s[32:39], s[0:1], 64
    s_load_dwordx4 s[40:43], s[0:1], 96
    v_mov_b32 v8, 0
    s_and_b32 s3, s2, 7
    s_lshr_b32 s4, s2, 3
    s_and_b32 s5, s4, 15
    v_and_b32 v1, 63, v0
    v_lshrrev_b32 v10, 6, v0
    s_nop 0
    v_readfirstlane_b32 s6, v10
    v_lshrrev_b32 v2, 3, v1
    v_lshrrev_b32 v10, 1, v1
    v_lshrrev_b32 v11, 4, v1
    v_xor_b32 v10, v10, v11
    v_and_b32 v10, 3, v10
    v_lshlrev_b32 v10, 5, v10
    v_and_b32 v12, 1, v1
    v_lshl_add_u32 v3, v12, 4, v10
    v_mul_u32_u24 v26, 12288, v2
    v_add_u32 v26, v26, v3
    s_lshl_b32 s98, s6, 11
    v_lshlrev_b32 v5, 4, v11
    v_lshlrev_b32 v7, 4, v1
    v_lshlrev_b32 v13, 3, v0
    s_lshr_b32 s97, s4, 2
    s_mul_i32 s97, s97, 1572864
    s_mul_i32 s14, s6, 196608
    s_add_u32 s97, s97, s14
    s_bfe_u32 s14, s4, 0x10001
    s_lshl_b32 s14, s14, 11
    s_add_u32 s97, s97, s14
    s_lshl_b32 s14, s3, 8
    s_add_u32 s97, s97, s14
    s_bfe_u32 s14, s4, 0x10000
    s_lshl_b32 s14, s14, 7
    s_add_u32 s97, s97, s14
    s_add_u32 s84, s97, 98304
    s_mov_b32 s78, 2048
    s_mov_b32 s79, 0x00020000
    s_mov_b32 s50, 0xc00000
    s_mov_b32 s51, 0x00020000
    s_add_u32 m0, s98, 141312
    s_waitcnt lgkmcnt(0)
    s_mov_b64 s[76:77], s[34:35]
    s_mov_b64 s[48:49], s[36:37]
    buffer_load_dwordx2 v[12:13], v13, s[76:79], 0 offen
    buffer_load_dwordx4 v26, s[48:51], s97 offen nt lds
    s_add_u32 m0, s98, 142336
    s_nop 0
    buffer_load_dwordx4 v26, s[48:51], s84 offen nt lds
    s_load_dword s7, s[42:43], 0
    s_mov_b32 s72, s16
    s_mov_b32 s73, s17
    s_mov_b32 s74, 0x800
    s_mov_b32 s75, 0x00020000
    s_mov_b32 s44, s42
    s_mov_b32 s45, s43
    s_mov_b32 s46, 0x500000
    s_mov_b32 s47, 0x00020000
    s_cmp_ge_u32 s4, 16
    s_cbranch_scc1 L_classB
    s_cmp_eq_u32 s6, 7
    s_cbranch_scc0 L_nosmall
    v_lshlrev_b32 v11, 2, v1
    v_lshlrev_b32 v10, 5, v1
    buffer_load_dwordx4 v[32:35], v10, s[72:75], 0 offen
    buffer_load_dwordx4 v[36:39], v10, s[72:75], 0 offen offset:16
    s_lshl_b32 s14, s3, 8
    buffer_load_dword v40, v11, s[72:75], s14 offen
L_nosmall:
    s_cmp_ge_u32 s4, 16
    s_cbranch_scc1 L_classB
    s_mov_b32 s52, s22
    s_mov_b32 s53, s23
    s_mov_b32 s54, 0x800000
    s_mov_b32 s55, 0x00020000
    v_lshl_add_u32 v15, v2, 13, v3
    s_lshl_b32 s97, s3, 20
    s_lshl_b32 s14, s6, 17
    s_add_u32 s97, s97, s14
    s_lshl_b32 s14, s5, 9
    s_add_u32 s97, s97, s14
    s_barrier
    s_add_u32 s84, s97, 0
    s_add_u32 m0, s98, 10240
    s_nop 0
    buffer_load_dwordx4 v15, s[52:55], s84 offen nt lds
    s_add_u32 s84, s97, 128
    s_add_u32 m0, s98, 26624
    s_nop 0
    buffer_load_dwordx4 v15, s[52:55], s84 offen nt lds
    s_add_u32 s84, s97, 256
    s_add_u32 m0, s98, 43008
    s_nop 0
    buffer_load_dwordx4 v15, s[52:55], s84 offen nt lds
    s_add_u32 s84, s97, 384
    s_add_u32 m0, s98, 59392
    s_nop 0
    buffer_load_dwordx4 v15, s[52:55], s84 offen nt lds
    s_mov_b32 s88, 0x3fb8aa3b
    s_mov_b32 s89, 0xffff0000
    v_lshrrev_b32 v10, 2, v1
    v_lshlrev_b32 v14, 9, v10
    v_lshlrev_b32 v10, 7, v10
    v_and_b32 v11, 3, v2
    v_lshl_add_u32 v10, v11, 5, v10
    v_and_b32 v11, 3, v1
    v_lshl_add_u32 v4, v11, 3, v10
    v_lshl_add_u32 v27, v11, 4, v14
    v_mov_b32 v6, 0xffffff00
    v_mov_b32 v24, v5
    s_mov_b32 exec_lo, 0xfffefffe
    s_mov_b32 exec_hi, 0xfffefffe
    v_mov_b32 v24, 0x80000000
    s_mov_b64 exec, -1
    s_bfe_u32 s14, s6, 0x20000
    s_lshl_b32 s14, s14, 5
    v_xor_b32 v25, s14, v4
    s_cmp_ge_u32 s6, 4
    s_cbranch_scc1 L_A_nosilu
    v_and_b32 v10, 3, v0
    v_lshlrev_b32 v10, 4, v10
    v_and_b32 v11, 4, v0
    v_lshl_add_u32 v10, v11, 1, v10
    v_lshrrev_b32 v11, 3, v0
    v_lshl_add_u32 v10, v11, 6, v10
    s_waitcnt vmcnt(6)
    v_lshlrev_b32 v16, 16, v12
    v_and_b32 v17, s89, v12
    v_lshlrev_b32 v18, 16, v13
    v_and_b32 v19, s89, v13
    v_mul_f32 v20, s88, v16
    v_mul_f32 v21, s88, v17
    v_mul_f32 v22, s88, v18
    v_mul_f32 v23, s88, v19
    v_exp_f32 v20, -v20
    v_exp_f32 v21, -v21
    v_exp_f32 v22, -v22
    v_exp_f32 v23, -v23
    v_add_f32 v20, 1.0, v20
    v_add_f32 v21, 1.0, v21
    v_add_f32 v22, 1.0, v22
    v_add_f32 v23, 1.0, v23
    v_rcp_f32 v20, v20
    v_rcp_f32 v21, v21
    v_rcp_f32 v22, v22
    v_rcp_f32 v23, v23
    v_mul_f32 v16, v16, v20
    v_mul_f32 v17, v17, v21
    v_mul_f32 v18, v18, v22
    v_mul_f32 v19, v19, v23
    v_cvt_pk_bf16_f32 v16, v16, v17
    v_cvt_pk_bf16_f32 v17, v18, v19
    ds_write_b64 v10, v[16:17] offset:0
    s_lshr_b32 s15, s4, 2
    s_lshl_b32 s15, s15, 8
    v_add_u32 v11, s15, v5
    v_add_u32 v10, 141312, v25
    s_lshl_b32 s94, s3, 13
    s_lshl_b32 s14, s4, 8
    s_add_u32 s94, s94, s14
    s_lshl_b32 s14, s6, 6
    s_add_u32 s94, s94, s14
    s_add_u32 s94, s94, 0x100000
    s_add_u32 s95, s94, 0x100000
L_A_nosilu:
L_A_nosilu2:
    s_waitcnt lgkmcnt(0)
    s_and_b32 s14, s7, 0x7f7f7f7f
    s_add_u32 s14, s14, 0x0b255301
    s_and_b32 s15, s7, 0x80808080
    s_xor_b32 s7, s14, s15
    s_bfe_u32 s8, s7, 0x80000
    s_bfe_u32 s9, s7, 0x80008
    s_bfe_u32 s10, s7, 0x80010
    s_bfe_u32 s11, s7, 0x80018
    s_waitcnt vmcnt(4)
    s_barrier
    s_cmp_ge_u32 s6, 4
    s_cbranch_scc1 L_A_nop0
    ds_read_b128 v[48:51], v11 offset:0
    ds_read_b64_tr_b16 v[80:81], v10 offset:0
    ds_read_b64_tr_b16 v[82:83], v10 offset:2048
    ds_read_b128 v[52:55], v11 offset:64
    ds_read_b64_tr_b16 v[84:85], v10 offset:4096
    ds_read_b64_tr_b16 v[86:87], v10 offset:6144
    ds_read_b128 v[56:59], v11 offset:128
    ds_read_b64_tr_b16 v[88:89], v10 offset:8192
    ds_read_b64_tr_b16 v[90:91], v10 offset:10240
    ds_read_b128 v[60:63], v11 offset:192
    ds_read_b64_tr_b16 v[92:93], v10 offset:12288
    ds_read_b64_tr_b16 v[94:95], v10 offset:14336
    s_waitcnt lgkmcnt(9)
    v_mfma_f32_16x16x32_bf16 v[64:67], v[80:83], v[48:51], 0
    s_waitcnt lgkmcnt(6)
    v_mfma_f32_16x16x32_bf16 v[64:67], v[84:87], v[52:55], v[64:67]
    s_waitcnt lgkmcnt(3)
    v_mfma_f32_16x16x32_bf16 v[64:67], v[88:91], v[56:59], v[64:67]
    s_waitcnt lgkmcnt(0)
    v_mfma_f32_16x16x32_bf16 v[64:67], v[92:95], v[60:63], v[64:67]
    s_nop 7
    v_and_or_b32 v68, v64, v6, s8
    v_and_or_b32 v69, v65, v6, s9
    v_and_or_b32 v70, v66, v6, s10
    v_and_or_b32 v71, v67, v6, s11
    buffer_store_dwordx4 v[68:71], v24, s[44:47], s94 offen
    buffer_store_dwordx4 v[68:71], v24, s[44:47], s95 offen sc1
L_A_nop0:
    s_add_u32 s84, s97, 65536
    s_add_u32 m0, s98, 11264
    s_nop 0
    buffer_load_dwordx4 v15, s[52:55], s84 offen nt lds
    s_add_u32 s84, s97, 65664
    s_add_u32 m0, s98, 27648
    s_nop 0
    buffer_load_dwordx4 v15, s[52:55], s84 offen nt lds
    s_add_u32 s84, s97, 65792
    s_add_u32 m0, s98, 44032
    s_nop 0
    buffer_load_dwordx4 v15, s[52:55], s84 offen nt lds
    s_add_u32 s84, s97, 65920
    s_add_u32 m0, s98, 60416
    s_nop 0
    buffer_load_dwordx4 v15, s[52:55], s84 offen nt lds
    s_cmp_eq_u32 s6, 5
    s_cbranch_scc0 L_nopf
    s_cmp_eq_u32 s5, 15
    s_cbranch_scc0 L_nopf
    s_getpc_b64 s[64:65]
L_pc:
    v_lshlrev_b32 v10, 7, v1
    v_min_u32 v11, L_end-L_pc, v10
    global_load_dword v44, v11, s[64:65]
    v_add_u32 v10, 8192, v10
    v_min_u32 v11, L_end-L_pc, v10
    global_load_dword v45, v11, s[64:65]
    v_add_u32 v10, 8192, v10
    v_min_u32 v11, L_end-L_pc, v10
    global_load_dword v46, v11, s[64:65]
L_nopf:
    s_cmp_eq_u32 s6, 7
    s_cbranch_scc0 L_A_noln
    v_lshlrev_b32 v48, 16, v32
    v_and_b32 v49, s89, v32
    v_lshlrev_b32 v50, 16, v33
    v_and_b32 v51, s89, v33
    v_lshlrev_b32 v52, 16, v34
    v_and_b32 v53, s89, v34
    v_lshlrev_b32 v54, 16, v35
    v_and_b32 v55, s89, v35
    v_lshlrev_b32 v56, 16, v36
    v_and_b32 v57, s89, v36
    v_lshlrev_b32 v58, 16, v37
    v_and_b32 v59, s89, v37
    v_lshlrev_b32 v60, 16, v38
    v_and_b32 v61, s89, v38
    v_lshlrev_b32 v62, 16, v39
    v_and_b32 v63, s89, v39
    v_pk_add_f32 v[64:65], v[48:49], v[50:51]
    v_pk_add_f32 v[66:67], v[52:53], v[54:55]
    v_pk_add_f32 v[68:69], v[56:57], v[58:59]
    v_pk_add_f32 v[70:71], v[60:61], v[62:63]
    v_pk_add_f32 v[64:65], v[64:65], v[66:67]
    v_pk_add_f32 v[68:69], v[68:69], v[70:71]
    v_pk_add_f32 v[64:65], v[64:65], v[68:69]
    v_add_f32 v64, v64, v65
    s_nop 1
    v_add_f32_dpp v64, v64, v64 quad_perm:[1,0,3,2] row_mask:0xf bank_mask:0xf
    s_nop 1
    v_add_f32_dpp v64, v64, v64 quad_perm:[2,3,0,1] row_mask:0xf bank_mask:0xf
    s_nop 1
    v_add_f32_dpp v64, v64, v64 row_half_mirror row_mask:0xf bank_mask:0xf
    s_nop 1
    v_add_f32_dpp v64, v64, v64 row_mirror row_mask:0xf bank_mask:0xf
    v_mov_b32 v65, v64
    s_nop 1
    v_permlane16_swap_b32 v65, v64
    v_add_f32 v64, v64, v65
    v_mov_b32 v65, v64
    s_nop 1
    v_permlane32_swap_b32 v65, v64
    v_add_f32 v64, v64, v65
    v_mul_f32 v64, 0xba800000, v64
    v_mov_b32 v65, v64
    v_pk_add_f32 v[48:49], v[48:49], v[64:65]
    v_pk_add_f32 v[50:51], v[50:51], v[64:65]
    v_pk_add_f32 v[52:53], v[52:53], v[64:65]
    v_pk_add_f32 v[54:55], v[54:55], v[64:65]
    v_pk_add_f32 v[56:57], v[56:57], v[64:65]
    v_pk_add_f32 v[58:59], v[58:59], v[64:65]
    v_pk_add_f32 v[60:61], v[60:61], v[64:65]
    v_pk_add_f32 v[62:63], v[62:63], v[64:65]
    v_pk_mul_f32 v[66:67], v[48:49], v[48:49]
    v_pk_fma_f32 v[66:67], v[50:51], v[50:51], v[66:67]
    v_pk_fma_f32 v[66:67], v[52:53], v[52:53], v[66:67]
    v_pk_fma_f32 v[66:67], v[54:55], v[54:55], v[66:67]
    v_pk_fma_f32 v[66:67], v[56:57], v[56:57], v[66:67]
    v_pk_fma_f32 v[66:67], v[58:59], v[58:59], v[66:67]
    v_pk_fma_f32 v[66:67], v[60:61], v[60:61], v[66:67]
    v_pk_fma_f32 v[66:67], v[62:63], v[62:63], v[66:67]
    v_add_f32 v66, v66, v67
    s_nop 1
    v_add_f32_dpp v66, v66, v66 quad_perm:[1,0,3,2] row_mask:0xf bank_mask:0xf
    s_nop 1
    v_add_f32_dpp v66, v66, v66 quad_perm:[2,3,0,1] row_mask:0xf bank_mask:0xf
    s_nop 1
    v_add_f32_dpp v66, v66, v66 row_half_mirror row_mask:0xf bank_mask:0xf
    s_nop 1
    v_add_f32_dpp v66, v66, v66 row_mirror row_mask:0xf bank_mask:0xf
    v_mov_b32 v65, v66
    s_nop 1
    v_permlane16_swap_b32 v65, v66
    v_add_f32 v66, v66, v65
    v_mov_b32 v65, v66
    s_nop 1
    v_permlane32_swap_b32 v65, v66
    v_add_f32 v66, v66, v65
    v_mul_f32 v66, 0x3a800000, v66
    v_cvt_pk_bf16_f32 v64, 0, v64
    v_cvt_pk_bf16_f32 v66, 0, v66
    v_add_f32 v66, 0x3727c5ac, v66
    v_cvt_pk_bf16_f32 v66, 0, v66
    v_sqrt_f32 v66, v66
    s_nop 0
    v_cvt_pk_bf16_f32 v66, 0, v66
    v_rcp_f32 v67, v66
    v_lshlrev_b32 v72, 16, v40
    v_and_b32 v73, s89, v40
    v_add_f32 v72, v72, v64
    v_cvt_pk_bf16_f32 v72, 0, v72
    v_mul_f32 v72, v72, v67
    v_cvt_pk_bf16_f32 v72, 0, v72
    v_add_f32 v73, v73, v64
    v_cvt_pk_bf16_f32 v73, 0, v73
    v_mul_f32 v73, v73, v67
    v_cvt_pk_bf16_f32 v73, 0, v73
    v_lshlrev_b32 v10, 3, v1
    ds_write_b64 v10, v[72:73] offset:9216
    s_waitcnt lgkmcnt(0)
L_A_noln:
    v_mov_b32 v23, 1.0
    s_mov_b32 s56, s24
    s_mov_b32 s57, s25
    s_mov_b32 s58, 0x800000
    s_mov_b32 s59, 0x00020000
    s_mov_b32 s60, s32
    s_mov_b32 s61, s33
    s_mov_b32 s62, 0x700000
    s_mov_b32 s63, 0x00020000
    s_lshl_b32 s13, s3, 13
    s_lshl_b32 s14, s6, 6
    s_add_u32 s13, s13, s14
    s_add_u32 s13, s13, 0x100000
    v_and_b32 v10, 3, v1
    v_lshlrev_b32 v12, 4, v10
    v_lshrrev_b32 v13, 2, v5
    v_add_u32 v172, v13, v12
    s_lshl_b32 s15, s6, 6
    v_add_u32 v13, s15, v172
    v_lshrrev_b32 v14, 3, v5
    v_add_u32 v28, v12, v14
    s_lshr_b32 s15, s6, 1
    s_lshl_b32 s15, s15, 6
    s_bfe_u32 s14, s6, 0x10000
    s_lshl_b32 s14, s14, 3
    s_add_u32 s15, s15, s14
    v_add_u32 v28, s15, v28
    v_add_u32 v29, 2048, v28
    s_mov_b32 exec_lo, 0xf0f0f0f0
    s_mov_b32 exec_hi, 0xf0f0f0f0
    v_mov_b32 v29, 3904
    s_mov_b64 exec, -1
    s_bfe_u32 s14, s6, 0x10000
    s_lshl_b32 s14, s14, 6
    v_xor_b32 v30, s14, v4
    s_lshr_b32 s15, s6, 1
    s_lshl_b32 s15, s15, 14
    s_add_u32 s15, s15, 0x2800
    v_add_u32 v30, s15, v30
    v_xor_b32 v31, 32, v30
    v_and_b32 v10, 1, v1
    v_lshl_add_u32 v22, v10, 6, v5
    s_mov_b32 exec_lo, 0xfffcfffc
    s_mov_b32 exec_hi, 0xfffcfffc
    v_mov_b32 v22, 0x80000000
    s_mov_b64 exec, -1
    s_lshl_b32 s94, s5, 13
    s_lshr_b32 s14, s6, 2
    s_lshl_b32 s14, s14, 12
    s_add_u32 s94, s94, s14
    s_lshl_b32 s14, s3, 9
    s_add_u32 s94, s94, s14
    s_bfe_u32 s14, s6, 0x20000
    s_lshl_b32 s14, s14, 7
    s_add_u32 s94, s94, s14
    s_add_u32 s94, s94, 0x10000
    s_lshr_b32 s95, s5, 2
    s_lshl_b32 s95, s95, 12
    s_lshl_b32 s14, s3, 9
    s_add_u32 s95, s95, s14
    s_bfe_u32 s14, s5, 0x20000
    s_lshl_b32 s14, s14, 7
    s_add_u32 s95, s95, s14
    s_add_u32 s95, s95, 0x1000
    v_mov_b32 v169, 0
    s_mov_b32 exec_lo, 0xfffffffe
    s_mov_b32 exec_hi, 0xffffffff
    v_mov_b32 v169, 0x80000000
    s_mov_b64 exec, -1
    v_mov_b32 v168, s7
    s_barrier
    ds_read_b32 v21, v13 offset:9216
    s_waitcnt vmcnt(3)
    s_mov_b32 s12, 0
L_poll_1:
    buffer_load_dwordx4 v[32:35], v27, s[44:47], s13 offen sc1
    s_waitcnt vmcnt(0)
    v_xor_b32 v32, s8, v32
    v_xor_b32 v33, s9, v33
    v_xor_b32 v34, s10, v34
    v_xor_b32 v35, s11, v35
    v_or3_b32 v9, v32, v33, v34
    v_or_b32 v9, v9, v35
    v_and_b32 v9, 0xff, v9
    v_cmp_ne_u32 vcc, 0, v9
    s_cbranch_vccz L_done_2
    s_add_u32 s12, s12, 1
    s_cmp_eq_u32 s12, 400
    s_cselect_b32 s14, 0x100000, 0
    s_add_u32 s13, s13, s14
    s_cmp_ge_u32 s12, 200000
    s_cbranch_scc1 L_done_2
    s_sleep 1
    s_branch L_poll_1
L_done_2:
    v_permlane32_swap_b32 v32, v34
    v_permlane32_swap_b32 v33, v35
    v_pk_add_f32 v[32:33], v[32:33], v[34:35]
    s_nop 1
    v_permlane16_swap_b32 v32, v33
    v_add_f32 v36, v32, v33
    s_nop 1
    v_add_f32_dpp v36, v36, v36 row_ror:8 row_mask:0xf bank_mask:0xf
    v_cvt_pk_bf16_f32 v36, 0, v36
    s_nop 1
    v_add_f32_dpp v37, v36, v23 row_ror:4 row_mask:0xf bank_mask:0xf
    v_cvt_pk_bf16_f32 v37, 0, v37
    s_waitcnt lgkmcnt(0)
    v_mul_f32 v37, v37, v21
    v_cvt_pk_bf16_f32 v37, 0, v37
    v_add_f32 v37, v37, v36
    v_cvt_pk_bf16_f32 v37, v37, v37
    ds_write_b16 v29, v37
    s_lshr_b32 s86, s6, 2
    s_mul_i32 s15, s5, 786432
    s_lshr_b32 s14, s86, 1
    s_lshl_b32 s14, s14, 11
    s_add_u32 s15, s15, s14
    s_lshl_b32 s14, s3, 8
    s_add_u32 s15, s15, s14
    s_bfe_u32 s14, s86, 0x10000
    s_lshl_b32 s14, s14, 7
    s_add_u32 s15, s15, s14
    s_bfe_u32 s14, s6, 0x20000
    s_mul_i32 s14, s14, 196608
    s_add_u32 s15, s15, s14
    s_add_u32 s15, s15, 0x1000
    s_lshl_b32 s87, s86, 13
    s_bfe_u32 s14, s6, 0x20000
    s_lshl_b32 s14, s14, 11
    s_add_u32 s87, s87, s14
    s_add_u32 s84, s15, 0
    s_add_u32 m0, s87, 141312
    s_nop 0
    buffer_load_dwordx4 v26, s[48:51], s84 offen nt lds
    s_add_u32 s84, s15, 98304
    s_add_u32 m0, s87, 142336
    s_nop 0
    buffer_load_dwordx4 v26, s[48:51], s84 offen nt lds
    s_waitcnt lgkmcnt(0)
    s_barrier
    ds_read_b128 v[48:51], v5 offset:2048
    ds_read_b64_tr_b16 v[96:97], v30 offset:0
    ds_read_b64_tr_b16 v[98:99], v30 offset:2048
    ds_read_b64_tr_b16 v[112:113], v31 offset:0
    ds_read_b64_tr_b16 v[114:115], v31 offset:2048
    ds_read_b128 v[52:55], v5 offset:2112
    ds_read_b64_tr_b16 v[100:101], v30 offset:4096
    ds_read_b64_tr_b16 v[102:103], v30 offset:6144
    ds_read_b64_tr_b16 v[116:117], v31 offset:4096
    ds_read_b64_tr_b16 v[118:119], v31 offset:6144
    s_waitcnt lgkmcnt(5)
    v_mfma_f32_16x16x32_bf16 v[64:67], v[96:99], v[48:51], 0
    v_mfma_f32_16x16x32_bf16 v[72:75], v[112:115], v[48:51], 0
    ds_read_b128 v[56:59], v5 offset:2176
    ds_read_b64_tr_b16 v[104:105], v30 offset:8192
    ds_read_b64_tr_b16 v[106:107], v30 offset:10240
    ds_read_b64_tr_b16 v[120:121], v31 offset:8192
    ds_read_b64_tr_b16 v[122:123], v31 offset:10240
    s_waitcnt lgkmcnt(5)
    v_mfma_f32_16x16x32_bf16 v[64:67], v[100:103], v[52:55], v[64:67]
    v_mfma_f32_16x16x32_bf16 v[72:75], v[116:119], v[52:55], v[72:75]
    ds_read_b128 v[60:63], v5 offset:2240
    ds_read_b64_tr_b16 v[108:109], v30 offset:12288
    ds_read_b64_tr_b16 v[110:111], v30 offset:14336
    ds_read_b64_tr_b16 v[124:125], v31 offset:12288
    ds_read_b64_tr_b16 v[126:127], v31 offset:14336
    s_waitcnt lgkmcnt(5)
    v_mfma_f32_16x16x32_bf16 v[64:67], v[104:107], v[56:59], v[64:67]
    v_mfma_f32_16x16x32_bf16 v[72:75], v[120:123], v[56:59], v[72:75]
    s_waitcnt lgkmcnt(0)
    v_mfma_f32_16x16x32_bf16 v[64:67], v[108:111], v[60:63], v[64:67]
    v_mfma_f32_16x16x32_bf16 v[72:75], v[124:127], v[60:63], v[72:75]
    s_nop 6
    v_and_or_b32 v68, v64, v6, s8
    v_and_or_b32 v69, v65, v6, s9
    v_and_or_b32 v70, v66, v6, s10
    v_and_or_b32 v71, v67, v6, s11
    s_mov_b32 exec_lo, 0x20002
    s_mov_b32 exec_hi, 0x20002
    v_and_or_b32 v68, v72, v6, s8
    v_and_or_b32 v69, v73, v6, s9
    v_and_or_b32 v70, v74, v6, s10
    v_and_or_b32 v71, v75, v6, s11
    s_mov_b64 exec, -1
    buffer_store_dwordx4 v[68:71], v22, s[44:47], s94 offen sc1
    s_barrier
    s_lshr_b32 s86, s6, 2
    s_mul_i32 s15, s5, 786432
    s_lshr_b32 s14, s86, 1
    s_lshl_b32 s14, s14, 11
    s_add_u32 s15, s15, s14
    s_lshl_b32 s14, s3, 8
    s_add_u32 s15, s15, s14
    s_bfe_u32 s14, s86, 0x10000
    s_lshl_b32 s14, s14, 7
    s_add_u32 s15, s15, s14
    s_bfe_u32 s14, s6, 0x20000
    s_mul_i32 s14, s14, 196608
    s_add_u32 s15, s15, s14
    s_add_u32 s15, s15, 0x1800
    s_lshl_b32 s87, s86, 13
    s_bfe_u32 s14, s6, 0x20000
    s_lshl_b32 s14, s14, 11
    s_add_u32 s87, s87, s14
    s_add_u32 s84, s15, 0
    s_add_u32 m0, s87, 10240
    s_nop 0
    buffer_load_dwordx4 v26, s[48:51], s84 offen nt lds
    s_add_u32 s84, s15, 98304
    s_add_u32 m0, s87, 11264
    s_nop 0
    buffer_load_dwordx4 v26, s[48:51], s84 offen nt lds
    s_lshr_b32 s86, s6, 2
    s_mul_i32 s15, s5, 786432
    s_lshr_b32 s14, s86, 1
    s_lshl_b32 s14, s14, 11
    s_add_u32 s15, s15, s14
    s_lshl_b32 s14, s3, 8
    s_add_u32 s15, s15, s14
    s_bfe_u32 s14, s86, 0x10000
    s_lshl_b32 s14, s14, 7
    s_add_u32 s15, s15, s14
    s_bfe_u32 s14, s6, 0x20000
    s_mul_i32 s14, s14, 196608
    s_add_u32 s15, s15, s14
    s_add_u32 s15, s15, 0x2000
    s_lshl_b32 s87, s86, 13
    s_bfe_u32 s14, s6, 0x20000
    s_lshl_b32 s14, s14, 11
    s_add_u32 s87, s87, s14
    s_add_u32 s84, s15, 0
    s_add_u32 m0, s87, 26624
    s_nop 0
    buffer_load_dwordx4 v26, s[48:51], s84 offen nt lds
    s_add_u32 s84, s15, 98304
    s_add_u32 m0, s87, 27648
    s_nop 0
    buffer_load_dwordx4 v26, s[48:51], s84 offen nt lds
    v_lshl_add_u32 v15, v2, 11, v3
    s_lshl_b32 s99, s3, 2
    s_lshr_b32 s14, s5, 2
    s_add_u32 s99, s99, s14
    s_lshl_b32 s15, s99, 18
    s_lshl_b32 s14, s6, 15
    s_add_u32 s15, s15, s14
    s_bfe_u32 s14, s5, 0x20000
    s_lshl_b32 s14, s14, 9
    s_add_u32 s15, s15, s14
    s_waitcnt vmcnt(1)
    s_barrier
    s_add_u32 s84, s15, 0
    s_add_u32 m0, s98, 75776
    s_nop 0
    buffer_load_dwordx4 v15, s[56:59], s84 offen nt lds
    s_add_u32 s84, s15, 128
    s_add_u32 m0, s98, 92160
    s_nop 0
    buffer_load_dwordx4 v15, s[56:59], s84 offen nt lds
    s_add_u32 s84, s15, 256
    s_add_u32 m0, s98, 108544
    s_nop 0
    buffer_load_dwordx4 v15, s[56:59], s84 offen nt lds
    s_add_u32 s84, s15, 384
    s_add_u32 m0, s98, 124928
    s_nop 0
    buffer_load_dwordx4 v15, s[56:59], s84 offen nt lds
    s_add_u32 s84, s15, 16384
    s_add_u32 m0, s98, 76800
    s_nop 0
    buffer_load_dwordx4 v15, s[56:59], s84 offen nt lds
    s_add_u32 s84, s15, 16512
    s_add_u32 m0, s98, 93184
    s_nop 0
    buffer_load_dwordx4 v15, s[56:59], s84 offen nt lds
    s_add_u32 s84, s15, 16640
    s_add_u32 m0, s98, 109568
    s_nop 0
    buffer_load_dwordx4 v15, s[56:59], s84 offen nt lds
    s_add_u32 s84, s15, 16768
    s_add_u32 m0, s98, 125952
    s_nop 0
    buffer_load_dwordx4 v15, s[56:59], s84 offen nt lds
    s_waitcnt vmcnt(8)
    s_barrier
    s_cmp_ge_u32 s6, 2
    s_cbranch_scc1 L_A_noga
    s_lshl_b32 s15, s5, 7
    v_add_u32 v56, s15, v5
    ds_read_b128 v[48:51], v56 offset:0
    ds_read_b128 v[52:55], v56 offset:64
    s_lshl_b32 s86, s3, 15
    s_lshr_b32 s14, s6, 1
    s_lshl_b32 s14, s14, 13
    s_add_u32 s86, s86, s14
    s_lshl_b32 s14, s5, 9
    s_add_u32 s86, s86, s14
    s_bfe_u32 s14, s6, 0x10000
    s_lshl_b32 s14, s14, 8
    s_add_u32 s86, s86, s14
    s_add_u32 s86, s86, 0x80000
    v_and_b32 v57, 15, v1
    v_lshl_add_u32 v57, v57, 6, v5
    s_mov_b32 exec_lo, 0xfff0fff0
    s_mov_b32 exec_hi, 0xfff0fff0
    v_mov_b32 v57, 0x80000000
    s_mov_b64 exec, -1
    s_lshl_b32 s87, s6, 13
    v_xor_b32 v58, 0, v4
    v_add_u32 v58, s87, v58
    v_xor_b32 v59, 32, v4
    v_add_u32 v59, s87, v59
    v_xor_b32 v60, 64, v4
    v_add_u32 v60, s87, v60
    v_xor_b32 v61, 96, v4
    v_add_u32 v61, s87, v61
    v_add_u32 v58, 141312, v58
    v_add_u32 v59, 141312, v59
    v_add_u32 v60, 141312, v60
    v_add_u32 v61, 141312, v61
    ds_read_b64_tr_b16 v[64:65], v58 offset:0
    ds_read_b64_tr_b16 v[66:67], v58 offset:2048
    ds_read_b64_tr_b16 v[68:69], v58 offset:4096
    ds_read_b64_tr_b16 v[70:71], v58 offset:6144
    ds_read_b64_tr_b16 v[72:73], v59 offset:0
    ds_read_b64_tr_b16 v[74:75], v59 offset:2048
    ds_read_b64_tr_b16 v[76:77], v59 offset:4096
    ds_read_b64_tr_b16 v[78:79], v59 offset:6144
    ds_read_b64_tr_b16 v[80:81], v60 offset:0
    ds_read_b64_tr_b16 v[82:83], v60 offset:2048
    ds_read_b64_tr_b16 v[84:85], v60 offset:4096
    ds_read_b64_tr_b16 v[86:87], v60 offset:6144
    ds_read_b64_tr_b16 v[88:89], v61 offset:0
    ds_read_b64_tr_b16 v[90:91], v61 offset:2048
    ds_read_b64_tr_b16 v[92:93], v61 offset:4096
    ds_read_b64_tr_b16 v[94:95], v61 offset:6144
    s_waitcnt lgkmcnt(0)
    v_mfma_f32_16x16x32_bf16 v[96:99], v[64:67], v[48:51], 0
    v_mfma_f32_16x16x32_bf16 v[96:99], v[68:71], v[52:55], v[96:99]
    v_mfma_f32_16x16x32_bf16 v[100:103], v[72:75], v[48:51], 0
    v_mfma_f32_16x16x32_bf16 v[100:103], v[76:79], v[52:55], v[100:103]
    v_mfma_f32_16x16x32_bf16 v[104:107], v[80:83], v[48:51], 0
    v_mfma_f32_16x16x32_bf16 v[104:107], v[84:87], v[52:55], v[104:107]
    v_mfma_f32_16x16x32_bf16 v[108:111], v[88:91], v[48:51], 0
    v_mfma_f32_16x16x32_bf16 v[108:111], v[92:95], v[52:55], v[108:111]
    s_mov_b32 exec_lo, 0x10001
    s_mov_b32 exec_hi, 0x10001
    v_and_or_b32 v112, v96, v6, s8
    v_and_or_b32 v113, v97, v6, s9
    v_and_or_b32 v114, v98, v6, s10
    v_and_or_b32 v115, v99, v6, s11
    s_mov_b32 exec_lo, 0x20002
    s_mov_b32 exec_hi, 0x20002
    v_and_or_b32 v112, v100, v6, s8
    v_and_or_b32 v113, v101, v6, s9
    v_and_or_b32 v114, v102, v6, s10
    v_and_or_b32 v115, v103, v6, s11
    s_mov_b32 exec_lo, 0x40004
    s_mov_b32 exec_hi, 0x40004
    v_and_or_b32 v112, v104, v6, s8
    v_and_or_b32 v113, v105, v6, s9
    v_and_or_b32 v114, v106, v6, s10
    v_and_or_b32 v115, v107, v6, s11
    s_mov_b32 exec_lo, 0x80008
    s_mov_b32 exec_hi, 0x80008
    v_and_or_b32 v112, v108, v6, s8
    v_and_or_b32 v113, v109, v6, s9
    v_and_or_b32 v114, v110, v6, s10
    v_and_or_b32 v115, v111, v6, s11
    s_mov_b64 exec, -1
    buffer_store_dwordx4 v[112:115], v57, s[44:47], s86 offen sc1
    s_branch L_A_noge
L_A_noga:
    s_cmp_ge_u32 s6, 6
    s_cbranch_scc1 L_A_noge
    s_lshl_b32 s15, s5, 7
    v_add_u32 v56, s15, v5
    ds_read_b128 v[48:51], v56 offset:0
    ds_read_b128 v[52:55], v56 offset:64
    s_lshl_b32 s86, s3, 15
    s_lshr_b32 s14, s6, 1
    s_lshl_b32 s14, s14, 13
    s_add_u32 s86, s86, s14
    s_lshl_b32 s14, s5, 9
    s_add_u32 s86, s86, s14
    s_bfe_u32 s14, s6, 0x10000
    s_lshl_b32 s14, s14, 8
    s_add_u32 s86, s86, s14
    s_add_u32 s86, s86, 0x80000
    v_and_b32 v57, 15, v1
    v_lshl_add_u32 v57, v57, 6, v5
    s_mov_b32 exec_lo, 0xfff0fff0
    s_mov_b32 exec_hi, 0xfff0fff0
    v_mov_b32 v57, 0x80000000
    s_mov_b64 exec, -1
    s_lshl_b32 s87, s6, 13
    v_xor_b32 v58, 0, v4
    v_add_u32 v58, s87, v58
    v_xor_b32 v59, 32, v4
    v_add_u32 v59, s87, v59
    v_xor_b32 v60, 64, v4
    v_add_u32 v60, s87, v60
    v_xor_b32 v61, 96, v4
    v_add_u32 v61, s87, v61
    v_add_u32 v58, -6144, v58
    v_add_u32 v59, -6144, v59
    v_add_u32 v60, -6144, v60
    v_add_u32 v61, -6144, v61
    ds_read_b64_tr_b16 v[64:65], v58 offset:0
    ds_read_b64_tr_b16 v[66:67], v58 offset:2048
    ds_read_b64_tr_b16 v[68:69], v58 offset:4096
    ds_read_b64_tr_b16 v[70:71], v58 offset:6144
    ds_read_b64_tr_b16 v[72:73], v59 offset:0
    ds_read_b64_tr_b16 v[74:75], v59 offset:2048
    ds_read_b64_tr_b16 v[76:77], v59 offset:4096
    ds_read_b64_tr_b16 v[78:79], v59 offset:6144
    ds_read_b64_tr_b16 v[80:81], v60 offset:0
    ds_read_b64_tr_b16 v[82:83], v60 offset:2048
    ds_read_b64_tr_b16 v[84:85], v60 offset:4096
    ds_read_b64_tr_b16 v[86:87], v60 offset:6144
    ds_read_b64_tr_b16 v[88:89], v61 offset:0
    ds_read_b64_tr_b16 v[90:91], v61 offset:2048
    ds_read_b64_tr_b16 v[92:93], v61 offset:4096
    ds_read_b64_tr_b16 v[94:95], v61 offset:6144
    s_waitcnt lgkmcnt(0)
    v_mfma_f32_16x16x32_bf16 v[96:99], v[64:67], v[48:51], 0
    v_mfma_f32_16x16x32_bf16 v[96:99], v[68:71], v[52:55], v[96:99]
    v_mfma_f32_16x16x32_bf16 v[100:103], v[72:75], v[48:51], 0
    v_mfma_f32_16x16x32_bf16 v[100:103], v[76:79], v[52:55], v[100:103]
    v_mfma_f32_16x16x32_bf16 v[104:107], v[80:83], v[48:51], 0
    v_mfma_f32_16x16x32_bf16 v[104:107], v[84:87], v[52:55], v[104:107]
    v_mfma_f32_16x16x32_bf16 v[108:111], v[88:91], v[48:51], 0
    v_mfma_f32_16x16x32_bf16 v[108:111], v[92:95], v[52:55], v[108:111]
    s_mov_b32 exec_lo, 0x10001
    s_mov_b32 exec_hi, 0x10001
    v_and_or_b32 v112, v96, v6, s8
    v_and_or_b32 v113, v97, v6, s9
    v_and_or_b32 v114, v98, v6, s10
    v_and_or_b32 v115, v99, v6, s11
    s_mov_b32 exec_lo, 0x20002
    s_mov_b32 exec_hi, 0x20002
    v_and_or_b32 v112, v100, v6, s8
    v_and_or_b32 v113, v101, v6, s9
    v_and_or_b32 v114, v102, v6, s10
    v_and_or_b32 v115, v103, v6, s11
    s_mov_b32 exec_lo, 0x40004
    s_mov_b32 exec_hi, 0x40004
    v_and_or_b32 v112, v104, v6, s8
    v_and_or_b32 v113, v105, v6, s9
    v_and_or_b32 v114, v106, v6, s10
    v_and_or_b32 v115, v107, v6, s11
    s_mov_b32 exec_lo, 0x80008
    s_mov_b32 exec_hi, 0x80008
    v_and_or_b32 v112, v108, v6, s8
    v_and_or_b32 v113, v109, v6, s9
    v_and_or_b32 v114, v110, v6, s10
    v_and_or_b32 v115, v111, v6, s11
    s_mov_b64 exec, -1
    buffer_store_dwordx4 v[112:115], v57, s[44:47], s86 offen sc1
L_A_noge:
    s_lshl_b32 s13, s99, 14
    s_lshl_b32 s14, s6, 6
    s_add_u32 s13, s13, s14
    s_add_u32 s13, s13, 0x400000
    s_lshr_b32 s96, s99, 3
    s_lshl_b32 s96, s96, 12
    s_bfe_u32 s14, s99, 0x30000
    s_lshl_b32 s14, s14, 4
    s_add_u32 s96, s96, s14
    s_add_u32 s96, s96, 0x8000
    v_lshrrev_b32 v10, 2, v1
    v_lshlrev_b32 v11, 8, v10
    v_lshl_add_u32 v10, v10, 9, v27
    s_bfe_u32 s94, s5, 0x20000
    s_lshl_b32 s94, s94, 15
    s_lshr_b32 s14, s6, 1
    s_lshl_b32 s14, s14, 13
    s_add_u32 s94, s94, s14
    s_lshl_b32 s14, s99, 8
    s_add_u32 s94, s94, s14
    s_bfe_u32 s14, s6, 0x10000
    s_lshl_b32 s14, s14, 7
    s_add_u32 s94, s94, s14
    s_add_u32 s94, s94, 0x30000
    v_add_u32 v30, 65536, v30
    v_add_u32 v31, 65536, v31
    s_waitcnt vmcnt(3)
    s_barrier
    s_mov_b32 s12, 0
L_poll_4:
    buffer_load_dwordx2 v[40:41], v11, s[44:47], s96 offen sc1
    buffer_load_dwordx2 v[42:43], v11, s[44:47], s96 offen offset:128 sc1
    s_waitcnt vmcnt(0)
    v_xor_b32 v40, s8, v40
    v_xor_b32 v41, s9, v41
    v_xor_b32 v42, s8, v42
    v_xor_b32 v43, s9, v43
    v_or3_b32 v9, v40, v41, v42
    v_or_b32 v9, v9, v43
    v_and_b32 v9, 0xff, v9
    v_cmp_ne_u32 vcc, 0, v9
    s_cbranch_vccz L_done_5
    s_add_u32 s12, s12, 1
    s_cmp_ge_u32 s12, 200000
    s_cbranch_scc1 L_done_5
    s_sleep 4
    s_branch L_poll_4
L_done_5:
    s_mov_b32 s12, 0
    buffer_load_dwordx4 v[32:35], v10, s[44:47], s13 offen sc1
    buffer_load_dwordx4 v[36:39], v10, s[44:47], s13 offen offset:512 sc1
    s_barrier
    ds_read_b64_tr_b16 v[128:129], v30 offset:0
    ds_read_b64_tr_b16 v[130:131], v30 offset:2048
    ds_read_b64_tr_b16 v[132:133], v30 offset:4096
    ds_read_b64_tr_b16 v[134:135], v30 offset:6144
    ds_read_b64_tr_b16 v[136:137], v30 offset:8192
    ds_read_b64_tr_b16 v[138:139], v30 offset:10240
    ds_read_b64_tr_b16 v[140:141], v30 offset:12288
    ds_read_b64_tr_b16 v[142:143], v30 offset:14336
    ds_read_b64_tr_b16 v[144:145], v31 offset:0
    ds_read_b64_tr_b16 v[146:147], v31 offset:2048
    ds_read_b64_tr_b16 v[148:149], v31 offset:4096
    ds_read_b64_tr_b16 v[150:151], v31 offset:6144
    ds_read_b64_tr_b16 v[152:153], v31 offset:8192
    ds_read_b64_tr_b16 v[154:155], v31 offset:10240
    ds_read_b64_tr_b16 v[156:157], v31 offset:12288
    ds_read_b64_tr_b16 v[158:159], v31 offset:14336
    v_max_f32 v64, v40, v42
    s_nop 1
    v_max_f32_dpp v64, v64, v64 row_ror:8 row_mask:0xf bank_mask:0xf
    s_nop 1
    v_max_f32_dpp v64, v64, v64 row_ror:4 row_mask:0xf bank_mask:0xf
    v_mov_b32 v65, v64
    s_nop 1
    v_permlane16_swap_b32 v65, v64
    v_max_f32 v64, v64, v65
    v_mov_b32 v65, v64
    s_nop 1
    v_permlane32_swap_b32 v65, v64
    v_max_f32 v64, v64, v65
    v_sub_f32 v66, v40, v64
    v_sub_f32 v68, v42, v64
    v_mul_f32 v66, s88, v66
    v_mul_f32 v68, s88, v68
    v_exp_f32 v66, v66
    v_exp_f32 v68, v68
    v_mul_f32 v74, v66, v41
    v_fmac_f32 v74, v68, v43
    s_nop 1
    v_add_f32_dpp v74, v74, v74 row_ror:8 row_mask:0xf bank_mask:0xf
    s_nop 1
    v_add_f32_dpp v74, v74, v74 row_ror:4 row_mask:0xf bank_mask:0xf
    v_mov_b32 v75, v74
    s_nop 1
    v_permlane16_swap_b32 v75, v74
    v_add_f32 v74, v74, v75
    v_mov_b32 v75, v74
    s_nop 1
    v_permlane32_swap_b32 v75, v74
    v_add_f32 v74, v74, v75
    v_rcp_f32 v74, v74
    s_nop 0
    v_mul_f32 v66, v66, v74
    v_mul_f32 v68, v68, v74
    s_waitcnt vmcnt(0)
    s_branch L_chk_9
L_poll_7:
    buffer_load_dwordx4 v[32:35], v10, s[44:47], s13 offen sc1
    buffer_load_dwordx4 v[36:39], v10, s[44:47], s13 offen offset:512 sc1
    s_waitcnt vmcnt(0)
L_chk_9:
    v_xor_b32 v32, s8, v32
    v_xor_b32 v33, s9, v33
    v_xor_b32 v34, s10, v34
    v_xor_b32 v35, s11, v35
    v_xor_b32 v36, s8, v36
    v_xor_b32 v37, s9, v37
    v_xor_b32 v38, s10, v38
    v_xor_b32 v39, s11, v39
    v_or3_b32 v9, v32, v33, v34
    v_or3_b32 v9, v9, v35, v36
    v_or3_b32 v9, v9, v37, v38
    v_or_b32 v9, v9, v39
    v_and_b32 v9, 0xff, v9
    v_cmp_ne_u32 vcc, 0, v9
    s_cbranch_vccz L_done_8
    s_add_u32 s12, s12, 1
    s_cmp_ge_u32 s12, 200000
    s_cbranch_scc1 L_done_8
    s_sleep 1
    s_branch L_poll_7
L_done_8:
    v_pk_mul_f32 v[76:77], v[32:33], v[66:67] op_sel_hi:[1,0]
    v_pk_mul_f32 v[78:79], v[34:35], v[66:67] op_sel_hi:[1,0]
    v_pk_fma_f32 v[76:77], v[36:37], v[68:69], v[76:77] op_sel_hi:[1,0,1]
    v_pk_fma_f32 v[78:79], v[38:39], v[68:69], v[78:79] op_sel_hi:[1,0,1]
    s_nop 1
    v_permlane32_swap_b32 v76, v78
    v_permlane32_swap_b32 v77, v79
    v_pk_add_f32 v[76:77], v[76:77], v[78:79]
    s_nop 1
    v_permlane16_swap_b32 v76, v77
    v_add_f32 v80, v76, v77
    s_nop 1
    v_add_f32_dpp v80, v80, v80 row_ror:8 row_mask:0xf bank_mask:0xf
    s_nop 1
    v_add_f32_dpp v80, v80, v80 row_ror:4 row_mask:0xf bank_mask:0xf
    v_cvt_pk_bf16_f32 v80, v80, v80
    ds_write_b16 v28, v80 offset:2304
    s_waitcnt lgkmcnt(0)
    s_barrier
    ds_read_b128 v[32:35], v5 offset:2304
    ds_read_b128 v[36:39], v5 offset:2368
    ds_read_b128 v[40:43], v5 offset:2432
    ds_read_b128 v[44:47], v5 offset:2496
    s_waitcnt lgkmcnt(3)
    v_mfma_f32_16x16x32_bf16 v[64:67], v[128:131], v[32:35], 0
    v_mfma_f32_16x16x32_bf16 v[72:75], v[144:147], v[32:35], 0
    s_waitcnt lgkmcnt(2)
    v_mfma_f32_16x16x32_bf16 v[64:67], v[132:135], v[36:39], v[64:67]
    v_mfma_f32_16x16x32_bf16 v[72:75], v[148:151], v[36:39], v[72:75]
    s_waitcnt lgkmcnt(1)
    v_mfma_f32_16x16x32_bf16 v[64:67], v[136:139], v[40:43], v[64:67]
    v_mfma_f32_16x16x32_bf16 v[72:75], v[152:155], v[40:43], v[72:75]
    s_waitcnt lgkmcnt(0)
    v_mfma_f32_16x16x32_bf16 v[64:67], v[140:143], v[44:47], v[64:67]
    v_mfma_f32_16x16x32_bf16 v[72:75], v[156:159], v[44:47], v[72:75]
    s_nop 6
    v_and_or_b32 v68, v64, v6, s8
    v_and_or_b32 v69, v65, v6, s9
    v_and_or_b32 v70, v66, v6, s10
    v_and_or_b32 v71, v67, v6, s11
    s_mov_b32 exec_lo, 0x20002
    s_mov_b32 exec_hi, 0x20002
    v_and_or_b32 v68, v72, v6, s8
    v_and_or_b32 v69, v73, v6, s9
    v_and_or_b32 v70, v74, v6, s10
    v_and_or_b32 v71, v75, v6, s11
    s_mov_b64 exec, -1
    buffer_store_dwordx4 v[68:71], v22, s[44:47], s94 offen sc1
    s_barrier
    s_lshr_b32 s86, s6, 2
    s_mul_i32 s15, s5, 786432
    s_lshr_b32 s14, s86, 1
    s_lshl_b32 s14, s14, 11
    s_add_u32 s15, s15, s14
    s_lshl_b32 s14, s3, 8
    s_add_u32 s15, s15, s14
    s_bfe_u32 s14, s86, 0x10000
    s_lshl_b32 s14, s14, 7
    s_add_u32 s15, s15, s14
    s_bfe_u32 s14, s6, 0x20000
    s_mul_i32 s14, s14, 196608
    s_add_u32 s15, s15, s14
    s_add_u32 s15, s15, 0x2800
    s_lshl_b32 s87, s86, 13
    s_bfe_u32 s14, s6, 0x20000
    s_lshl_b32 s14, s14, 11
    s_add_u32 s87, s87, s14
    s_add_u32 s84, s15, 0
    s_add_u32 m0, s87, 75776
    s_nop 0
    buffer_load_dwordx4 v26, s[48:51], s84 offen nt lds
    s_add_u32 s84, s15, 98304
    s_add_u32 m0, s87, 76800
    s_nop 0
    buffer_load_dwordx4 v26, s[48:51], s84 offen nt lds
    s_barrier
    s_mul_i32 s15, s3, 917504
    s_lshr_b32 s14, s5, 3
    s_mul_i32 s14, s14, 458752
    s_add_u32 s15, s15, s14
    s_bfe_u32 s14, s5, 0x30000
    s_lshl_b32 s14, s14, 8
    s_add_u32 s15, s15, s14
    s_mul_i32 s85, s6, 7
    s_add_u32 s86, s85, 0
    s_lshr_b32 s84, s86, 1
    s_lshl_b32 s84, s84, 14
    s_bfe_u32 s14, s86, 0x10000
    s_lshl_b32 s14, s14, 7
    s_add_u32 s84, s84, s14
    s_add_u32 s84, s84, s15
    s_lshr_b32 s87, s86, 1
    s_lshl_b32 s87, s87, 10
    s_bfe_u32 s14, s86, 0x10000
    s_mul_i32 s14, s14, 28672
    s_add_u32 s87, s87, s14
    s_add_u32 m0, s87, 10240
    s_nop 0
    buffer_load_dwordx4 v15, s[60:63], s84 offen nt lds
    s_add_u32 s86, s85, 1
    s_lshr_b32 s84, s86, 1
    s_lshl_b32 s84, s84, 14
    s_bfe_u32 s14, s86, 0x10000
    s_lshl_b32 s14, s14, 7
    s_add_u32 s84, s84, s14
    s_add_u32 s84, s84, s15
    s_lshr_b32 s87, s86, 1
    s_lshl_b32 s87, s87, 10
    s_bfe_u32 s14, s86, 0x10000
    s_mul_i32 s14, s14, 28672
    s_add_u32 s87, s87, s14
    s_add_u32 m0, s87, 10240
    s_nop 0
    buffer_load_dwordx4 v15, s[60:63], s84 offen nt lds
    s_add_u32 s86, s85, 2
    s_lshr_b32 s84, s86, 1
    s_lshl_b32 s84, s84, 14
    s_bfe_u32 s14, s86, 0x10000
    s_lshl_b32 s14, s14, 7
    s_add_u32 s84, s84, s14
    s_add_u32 s84, s84, s15
    s_lshr_b32 s87, s86, 1
    s_lshl_b32 s87, s87, 10
    s_bfe_u32 s14, s86, 0x10000
    s_mul_i32 s14, s14, 28672
    s_add_u32 s87, s87, s14
    s_add_u32 m0, s87, 10240
    s_nop 0
    buffer_load_dwordx4 v15, s[60:63], s84 offen nt lds
    s_waitcnt vmcnt(3)
    s_barrier
    s_cmp_ge_u32 s6, 2
    s_cbranch_scc1 L_A_nosc2
    s_lshl_b32 s15, s5, 7
    v_add_u32 v56, s15, v5
    ds_read_b128 v[48:51], v56 offset:0
    ds_read_b128 v[52:55], v56 offset:64
    s_lshl_b32 s86, s3, 15
    s_lshr_b32 s14, s6, 1
    s_lshl_b32 s14, s14, 13
    s_add_u32 s86, s86, s14
    s_lshl_b32 s14, s5, 9
    s_add_u32 s86, s86, s14
    s_bfe_u32 s14, s6, 0x10000
    s_lshl_b32 s14, s14, 8
    s_add_u32 s86, s86, s14
    s_add_u32 s86, s86, 0x86000
    v_and_b32 v57, 15, v1
    v_lshl_add_u32 v57, v57, 6, v5
    s_mov_b32 exec_lo, 0xfff0fff0
    s_mov_b32 exec_hi, 0xfff0fff0
    v_mov_b32 v57, 0x80000000
    s_mov_b64 exec, -1
    s_lshl_b32 s87, s6, 13
    v_xor_b32 v58, 0, v4
    v_add_u32 v58, s87, v58
    v_xor_b32 v59, 32, v4
    v_add_u32 v59, s87, v59
    v_xor_b32 v60, 64, v4
    v_add_u32 v60, s87, v60
    v_xor_b32 v61, 96, v4
    v_add_u32 v61, s87, v61
    v_add_u32 v58, 75776, v58
    v_add_u32 v59, 75776, v59
    v_add_u32 v60, 75776, v60
    v_add_u32 v61, 75776, v61
    ds_read_b64_tr_b16 v[64:65], v58 offset:0
    ds_read_b64_tr_b16 v[66:67], v58 offset:2048
    ds_read_b64_tr_b16 v[68:69], v58 offset:4096
    ds_read_b64_tr_b16 v[70:71], v58 offset:6144
    ds_read_b64_tr_b16 v[72:73], v59 offset:0
    ds_read_b64_tr_b16 v[74:75], v59 offset:2048
    ds_read_b64_tr_b16 v[76:77], v59 offset:4096
    ds_read_b64_tr_b16 v[78:79], v59 offset:6144
    ds_read_b64_tr_b16 v[80:81], v60 offset:0
    ds_read_b64_tr_b16 v[82:83], v60 offset:2048
    ds_read_b64_tr_b16 v[84:85], v60 offset:4096
    ds_read_b64_tr_b16 v[86:87], v60 offset:6144
    ds_read_b64_tr_b16 v[88:89], v61 offset:0
    ds_read_b64_tr_b16 v[90:91], v61 offset:2048
    ds_read_b64_tr_b16 v[92:93], v61 offset:4096
    ds_read_b64_tr_b16 v[94:95], v61 offset:6144
    s_waitcnt lgkmcnt(0)
    v_mfma_f32_16x16x32_bf16 v[96:99], v[64:67], v[48:51], 0
    v_mfma_f32_16x16x32_bf16 v[96:99], v[68:71], v[52:55], v[96:99]
    v_mfma_f32_16x16x32_bf16 v[100:103], v[72:75], v[48:51], 0
    v_mfma_f32_16x16x32_bf16 v[100:103], v[76:79], v[52:55], v[100:103]
    v_mfma_f32_16x16x32_bf16 v[104:107], v[80:83], v[48:51], 0
    v_mfma_f32_16x16x32_bf16 v[104:107], v[84:87], v[52:55], v[104:107]
    v_mfma_f32_16x16x32_bf16 v[108:111], v[88:91], v[48:51], 0
    v_mfma_f32_16x16x32_bf16 v[108:111], v[92:95], v[52:55], v[108:111]
    s_mov_b32 exec_lo, 0x10001
    s_mov_b32 exec_hi, 0x10001
    v_and_or_b32 v112, v96, v6, s8
    v_and_or_b32 v113, v97, v6, s9
    v_and_or_b32 v114, v98, v6, s10
    v_and_or_b32 v115, v99, v6, s11
    s_mov_b32 exec_lo, 0x20002
    s_mov_b32 exec_hi, 0x20002
    v_and_or_b32 v112, v100, v6, s8
    v_and_or_b32 v113, v101, v6, s9
    v_and_or_b32 v114, v102, v6, s10
    v_and_or_b32 v115, v103, v6, s11
    s_mov_b32 exec_lo, 0x40004
    s_mov_b32 exec_hi, 0x40004
    v_and_or_b32 v112, v104, v6, s8
    v_and_or_b32 v113, v105, v6, s9
    v_and_or_b32 v114, v106, v6, s10
    v_and_or_b32 v115, v107, v6, s11
    s_mov_b32 exec_lo, 0x80008
    s_mov_b32 exec_hi, 0x80008
    v_and_or_b32 v112, v108, v6, s8
    v_and_or_b32 v113, v109, v6, s9
    v_and_or_b32 v114, v110, v6, s10
    v_and_or_b32 v115, v111, v6, s11
    s_mov_b64 exec, -1
    buffer_store_dwordx4 v[112:115], v57, s[44:47], s86 offen sc1
L_A_nosc2:
    s_cmp_eq_u32 s6, 7
    s_cbranch_scc0 L_A_nor2
    s_lshl_b32 s13, s3, 11
    s_lshl_b32 s14, s5, 7
    s_add_u32 s13, s13, s14
    s_add_u32 s13, s13, 0x70000
    v_mov_b32 v12, 0
    s_mov_b32 s12, 0
L_pd_10:
    buffer_load_dword v32, v12, s[44:47], s13 offen sc1
    s_waitcnt vmcnt(0)
    v_xor_b32 v32, s7, v32
    v_cmp_ne_u32 vcc, 0, v32
    s_cbranch_vccz L_pdd_11
    s_add_u32 s12, s12, 1
    s_cmp_ge_u32 s12, 200000
    s_cbranch_scc1 L_pdd_11
    s_sleep 2
    s_branch L_pd_10
L_pdd_11:
L_A_nor2:
    s_barrier
    s_mul_i32 s15, s3, 917504
    s_lshr_b32 s14, s5, 3
    s_mul_i32 s14, s14, 458752
    s_add_u32 s15, s15, s14
    s_bfe_u32 s14, s5, 0x30000
    s_lshl_b32 s14, s14, 8
    s_add_u32 s15, s15, s14
    s_mul_i32 s85, s6, 7
    s_add_u32 s86, s85, 3
    s_lshr_b32 s84, s86, 1
    s_lshl_b32 s84, s84, 14
    s_bfe_u32 s14, s86, 0x10000
    s_lshl_b32 s14, s14, 7
    s_add_u32 s84, s84, s14
    s_add_u32 s84, s84, s15
    s_lshr_b32 s87, s86, 1
    s_lshl_b32 s87, s87, 10
    s_bfe_u32 s14, s86, 0x10000
    s_mul_i32 s14, s14, 28672
    s_add_u32 s87, s87, s14
    s_add_u32 m0, s87, 10240
    s_nop 0
    buffer_load_dwordx4 v15, s[60:63], s84 offen nt lds
    s_add_u32 s86, s85, 4
    s_lshr_b32 s84, s86, 1
    s_lshl_b32 s84, s84, 14
    s_bfe_u32 s14, s86, 0x10000
    s_lshl_b32 s14, s14, 7
    s_add_u32 s84, s84, s14
    s_add_u32 s84, s84, s15
    s_lshr_b32 s87, s86, 1
    s_lshl_b32 s87, s87, 10
    s_bfe_u32 s14, s86, 0x10000
    s_mul_i32 s14, s14, 28672
    s_add_u32 s87, s87, s14
    s_add_u32 m0, s87, 10240
    s_nop 0
    buffer_load_dwordx4 v15, s[60:63], s84 offen nt lds
    s_add_u32 s86, s85, 5
    s_lshr_b32 s84, s86, 1
    s_lshl_b32 s84, s84, 14
    s_bfe_u32 s14, s86, 0x10000
    s_lshl_b32 s14, s14, 7
    s_add_u32 s84, s84, s14
    s_add_u32 s84, s84, s15
    s_lshr_b32 s87, s86, 1
    s_lshl_b32 s87, s87, 10
    s_bfe_u32 s14, s86, 0x10000
    s_mul_i32 s14, s14, 28672
    s_add_u32 s87, s87, s14
    s_add_u32 m0, s87, 10240
    s_nop 0
    buffer_load_dwordx4 v15, s[60:63], s84 offen nt lds
    s_add_u32 s86, s85, 6
    s_lshr_b32 s84, s86, 1
    s_lshl_b32 s84, s84, 14
    s_bfe_u32 s14, s86, 0x10000
    s_lshl_b32 s14, s14, 7
    s_add_u32 s84, s84, s14
    s_add_u32 s84, s84, s15
    s_lshr_b32 s87, s86, 1
    s_lshl_b32 s87, s87, 10
    s_bfe_u32 s14, s86, 0x10000
    s_mul_i32 s14, s14, 28672
    s_add_u32 s87, s87, s14
    s_add_u32 m0, s87, 10240
    s_nop 0
    buffer_load_dwordx4 v15, s[60:63], s84 offen nt lds
    s_lshr_b32 s15, s6, 2
    s_mul_i32 s15, s15, 28672
    s_add_u32 s15, s15, 0x2800
    v_add_u32 v31, s15, v25
    s_bfe_u32 s94, s5, 0x30000
    s_lshl_b32 s94, s94, 14
    s_lshl_b32 s14, s6, 11
    s_add_u32 s94, s94, s14
    s_lshl_b32 s14, s3, 8
    s_add_u32 s94, s94, s14
    s_lshr_b32 s14, s5, 3
    s_lshl_b32 s14, s14, 7
    s_add_u32 s94, s94, s14
    s_add_u32 s94, s94, 0x50000
    s_mul_i32 s13, s3, 57344
    s_lshr_b32 s14, s5, 3
    s_mul_i32 s14, s14, 14336
    s_add_u32 s13, s13, s14
    s_lshl_b32 s14, s6, 11
    s_add_u32 s13, s13, s14
    s_add_u32 s13, s13, 0x160000
    v_and_b32 v10, 7, v1
    v_lshlrev_b32 v10, 4, v10
    v_lshl_add_u32 v10, v5, 5, v10
    v_and_b32 v11, 1, v2
    v_mul_u32_u24 v11, 28672, v11
    v_add_u32 v10, v10, v11
    v_and_b32 v29, 3, v1
    v_lshlrev_b32 v29, 4, v29
    v_and_b32 v13, 4, v1
    v_lshl_add_u32 v29, v13, 1, v29
    v_lshrrev_b32 v13, 3, v5
    v_add_u32 v29, v29, v13
    s_lshl_b32 s15, s6, 6
    s_add_u32 s15, s15, 0xb80
    v_add_u32 v29, s15, v29
    s_mov_b32 exec_lo, 0xff00ff00
    s_mov_b32 exec_hi, 0xff00ff00
    v_mov_b32 v29, 3904
    s_mov_b64 exec, -1
    s_waitcnt vmcnt(0)
L_A_w5l:
    s_barrier
    ds_read_b64_tr_b16 v[128:129], v31 offset:0
    ds_read_b64_tr_b16 v[130:131], v31 offset:2048
    ds_read_b64_tr_b16 v[132:133], v31 offset:4096
    ds_read_b64_tr_b16 v[134:135], v31 offset:6144
    ds_read_b64_tr_b16 v[136:137], v31 offset:8192
    ds_read_b64_tr_b16 v[138:139], v31 offset:10240
    ds_read_b64_tr_b16 v[140:141], v31 offset:12288
    ds_read_b64_tr_b16 v[142:143], v31 offset:14336
    ds_read_b64_tr_b16 v[144:145], v31 offset:16384
    ds_read_b64_tr_b16 v[146:147], v31 offset:18432
    ds_read_b64_tr_b16 v[148:149], v31 offset:20480
    ds_read_b64_tr_b16 v[150:151], v31 offset:22528
    ds_read_b64_tr_b16 v[152:153], v31 offset:24576
    ds_read_b64_tr_b16 v[154:155], v31 offset:26624
    s_cmp_eq_u32 s6, 7
    s_cbranch_scc1 L_A_noact
    s_mov_b32 s12, 0
L_poll_12:
    buffer_load_dwordx4 v[32:35], v10, s[44:47], s13 offen offset:0 sc1
    buffer_load_dwordx4 v[36:39], v10, s[44:47], s13 offen offset:128 sc1
    buffer_load_dwordx4 v[40:43], v10, s[44:47], s13 offen offset:256 sc1
    buffer_load_dwordx4 v[44:47], v10, s[44:47], s13 offen offset:384 sc1
    s_waitcnt vmcnt(0)
    v_xor_b32 v32, s8, v32
    v_xor_b32 v33, s9, v33
    v_xor_b32 v34, s10, v34
    v_xor_b32 v35, s11, v35
    v_xor_b32 v36, s8, v36
    v_xor_b32 v37, s9, v37
    v_xor_b32 v38, s10, v38
    v_xor_b32 v39, s11, v39
    v_xor_b32 v40, s8, v40
    v_xor_b32 v41, s9, v41
    v_xor_b32 v42, s10, v42
    v_xor_b32 v43, s11, v43
    v_xor_b32 v44, s8, v44
    v_xor_b32 v45, s9, v45
    v_xor_b32 v46, s10, v46
    v_xor_b32 v47, s11, v47
    v_or3_b32 v9, v32, v33, v34
    v_or3_b32 v9, v9, v35, v36
    v_or3_b32 v9, v9, v37, v38
    v_or3_b32 v9, v9, v39, v40
    v_or3_b32 v9, v9, v41, v42
    v_or3_b32 v9, v9, v43, v44
    v_or3_b32 v9, v9, v45, v46
    v_or_b32 v9, v9, v47
    v_and_b32 v9, 0xff, v9
    v_cmp_ne_u32 vcc, 0, v9
    s_cbranch_vccz L_done_13
    s_add_u32 s12, s12, 1
    s_cmp_eq_u32 s12, 400
    s_cselect_b32 s14, 0x100000, 0
    s_add_u32 s13, s13, s14
    s_cmp_ge_u32 s12, 200000
    s_cbranch_scc1 L_done_13
    s_sleep 1
    s_branch L_poll_12
L_done_13:
    v_pk_add_f32 v[32:33], v[32:33], v[36:37]
    v_pk_add_f32 v[34:35], v[34:35], v[38:39]
    v_pk_add_f32 v[40:41], v[40:41], v[44:45]
    v_pk_add_f32 v[42:43], v[42:43], v[46:47]
    v_pk_add_f32 v[48:49], v[32:33], v[40:41]
    v_pk_add_f32 v[50:51], v[34:35], v[42:43]
    s_nop 1
    v_permlane32_swap_b32 v48, v50
    v_permlane32_swap_b32 v49, v51
    v_pk_add_f32 v[48:49], v[48:49], v[50:51]
    s_nop 1
    v_permlane16_swap_b32 v48, v49
    v_add_f32 v52, v48, v49
    v_cvt_pk_bf16_f32 v52, 0, v52
    v_mul_f32 v54, s88, v52
    v_exp_f32 v54, -v54
    v_mov_b32_dpp v53, v52 row_ror:8 row_mask:0xf bank_mask:0xf
    v_add_f32 v54, 1.0, v54
    v_rcp_f32 v54, v54
    s_nop 0
    v_mul_f32 v52, v52, v54
    v_cvt_pk_bf16_f32 v52, 0, v52
    v_mul_f32 v52, v52, v53
    v_cvt_pk_bf16_f32 v52, v52, v52
    ds_write_b16 v29, v52
L_A_noact:
    s_waitcnt vmcnt(0) lgkmcnt(0)
    s_barrier
    ds_read_b128 v[32:35], v5 offset:2944
    ds_read_b128 v[36:39], v5 offset:3008
    ds_read_b128 v[40:43], v5 offset:3072
    ds_read_b128 v[44:47], v5 offset:3136
    ds_read_b128 v[48:51], v5 offset:3200
    ds_read_b128 v[52:55], v5 offset:3264
    ds_read_b128 v[56:59], v5 offset:3328
    s_waitcnt lgkmcnt(6)
    v_mfma_f32_16x16x32_bf16 v[64:67], v[128:131], v[32:35], 0
    s_waitcnt lgkmcnt(5)
    v_mfma_f32_16x16x32_bf16 v[64:67], v[132:135], v[36:39], v[64:67]
    s_waitcnt lgkmcnt(4)
    v_mfma_f32_16x16x32_bf16 v[64:67], v[136:139], v[40:43], v[64:67]
    s_waitcnt lgkmcnt(3)
    v_mfma_f32_16x16x32_bf16 v[64:67], v[140:143], v[44:47], v[64:67]
    s_waitcnt lgkmcnt(2)
    v_mfma_f32_16x16x32_bf16 v[64:67], v[144:147], v[48:51], v[64:67]
    s_waitcnt lgkmcnt(1)
    v_mfma_f32_16x16x32_bf16 v[64:67], v[148:151], v[52:55], v[64:67]
    s_waitcnt lgkmcnt(0)
    v_mfma_f32_16x16x32_bf16 v[64:67], v[152:155], v[56:59], v[64:67]
    s_nop 7
    v_and_or_b32 v68, v64, v6, s8
    v_and_or_b32 v69, v65, v6, s9
    v_and_or_b32 v70, v66, v6, s10
    v_and_or_b32 v71, v67, v6, s11
    buffer_store_dwordx4 v[68:71], v24, s[44:47], s94 offen sc1
    s_branch L_fin
L_classB:
    s_mov_b32 s56, s18
    s_mov_b32 s57, s19
    s_mov_b32 s58, 0x4000000
    s_mov_b32 s59, 0x00020000
    s_mov_b32 s60, s20
    s_mov_b32 s61, s21
    s_mov_b32 s62, 0x4000000
    s_mov_b32 s63, 0x00020000
    s_bfe_u32 s99, s3, 0x10000
    s_lshl_b32 s99, s99, 4
    s_add_u32 s99, s99, s5
    s_lshr_b32 s97, s3, 1
    s_lshl_b32 s97, s97, 24
    s_lshl_b32 s14, s99, 15
    s_add_u32 s97, s97, s14
    s_lshl_b32 s14, s6, 12
    s_add_u32 s97, s97, s14
    s_add_u32 s97, s97, 0xf00000
    v_and_b32 v14, 15, v1
    v_lshl_add_u32 v30, v14, 8, v5
    v_lshl_add_u32 v15, v2, 8, v3
    s_mov_b32 s88, 0x3fb8aa3b
    s_mov_b32 s89, 0xffff0000
    v_lshrrev_b32 v10, 2, v1
    v_lshlrev_b32 v14, 9, v10
    v_lshlrev_b32 v10, 7, v10
    v_and_b32 v11, 3, v2
    v_lshl_add_u32 v10, v11, 5, v10
    v_and_b32 v11, 3, v1
    v_lshl_add_u32 v4, v11, 3, v10
    v_lshl_add_u32 v27, v11, 4, v14
    v_mov_b32 v6, 0xffffff00
    v_mov_b32 v24, v5
    s_mov_b32 exec_lo, 0xfffefffe
    s_mov_b32 exec_hi, 0xfffefffe
    v_mov_b32 v24, 0x80000000
    s_mov_b64 exec, -1
    s_bfe_u32 s14, s6, 0x20000
    s_lshl_b32 s14, s14, 5
    v_xor_b32 v25, s14, v4
    s_cmp_ge_u32 s6, 4
    s_cbranch_scc1 L_B_nosilu
    v_and_b32 v10, 3, v0
    v_lshlrev_b32 v10, 4, v10
    v_and_b32 v11, 4, v0
    v_lshl_add_u32 v10, v11, 1, v10
    v_lshrrev_b32 v11, 3, v0
    v_lshl_add_u32 v10, v11, 6, v10
    s_waitcnt vmcnt(2)
    v_lshlrev_b32 v16, 16, v12
    v_and_b32 v17, s89, v12
    v_lshlrev_b32 v18, 16, v13
    v_and_b32 v19, s89, v13
    v_mul_f32 v20, s88, v16
    v_mul_f32 v21, s88, v17
    v_mul_f32 v22, s88, v18
    v_mul_f32 v23, s88, v19
    v_exp_f32 v20, -v20
    v_exp_f32 v21, -v21
    v_exp_f32 v22, -v22
    v_exp_f32 v23, -v23
    v_add_f32 v20, 1.0, v20
    v_add_f32 v21, 1.0, v21
    v_add_f32 v22, 1.0, v22
    v_add_f32 v23, 1.0, v23
    v_rcp_f32 v20, v20
    v_rcp_f32 v21, v21
    v_rcp_f32 v22, v22
    v_rcp_f32 v23, v23
    v_mul_f32 v16, v16, v20
    v_mul_f32 v17, v17, v21
    v_mul_f32 v18, v18, v22
    v_mul_f32 v19, v19, v23
    v_cvt_pk_bf16_f32 v16, v16, v17
    v_cvt_pk_bf16_f32 v17, v18, v19
    ds_write_b64 v10, v[16:17] offset:0
L_B_nosilu:
    s_cmp_eq_u32 s6, 6
    s_cbranch_scc0 L_B_not6
    v_lshlrev_b32 v11, 3, v1
    s_lshl_b32 s84, s3, 13
    s_lshl_b32 s14, s5, 9
    s_add_u32 s84, s84, s14
    s_add_u32 s84, s84, 0x100000
    buffer_load_dword v32, v11, s[44:47], s84 offen
L_B_not6:
L_B_nosilu2:
    s_lshr_b32 s15, s4, 2
    s_lshl_b32 s15, s15, 8
    v_add_u32 v11, s15, v5
    v_add_u32 v10, 141312, v25
    s_lshl_b32 s94, s3, 13
    s_lshl_b32 s14, s4, 8
    s_add_u32 s94, s94, s14
    s_lshl_b32 s14, s6, 6
    s_add_u32 s94, s94, s14
    s_add_u32 s94, s94, 0x100000
    s_add_u32 s95, s94, 0x100000
    s_lshr_b32 s15, s6, 2
    s_lshl_b32 s15, s15, 14
    s_add_u32 s15, s15, 0x2800
    v_add_u32 v31, s15, v25
    s_waitcnt lgkmcnt(0)
    s_and_b32 s14, s7, 0x7f7f7f7f
    s_add_u32 s14, s14, 0x0b255301
    s_and_b32 s15, s7, 0x80808080
    s_xor_b32 s7, s14, s15
    s_bfe_u32 s8, s7, 0x80000
    s_bfe_u32 s9, s7, 0x80008
    s_bfe_u32 s10, s7, 0x80010
    s_bfe_u32 s11, s7, 0x80018
    s_waitcnt vmcnt(1)
    s_cmp_eq_u32 s6, 6
    s_cbranch_scc1 L_B_w6
    s_waitcnt vmcnt(0)
L_B_w6:
    s_barrier
    s_cmp_ge_u32 s6, 4
    s_cbranch_scc1 L_B_nop0
    ds_read_b128 v[48:51], v11 offset:0
    ds_read_b64_tr_b16 v[80:81], v10 offset:0
    ds_read_b64_tr_b16 v[82:83], v10 offset:2048
    ds_read_b128 v[52:55], v11 offset:64
    ds_read_b64_tr_b16 v[84:85], v10 offset:4096
    ds_read_b64_tr_b16 v[86:87], v10 offset:6144
    ds_read_b128 v[56:59], v11 offset:128
    ds_read_b64_tr_b16 v[88:89], v10 offset:8192
    ds_read_b64_tr_b16 v[90:91], v10 offset:10240
    ds_read_b128 v[60:63], v11 offset:192
    ds_read_b64_tr_b16 v[92:93], v10 offset:12288
    ds_read_b64_tr_b16 v[94:95], v10 offset:14336
    s_waitcnt lgkmcnt(9)
    v_mfma_f32_16x16x32_bf16 v[64:67], v[80:83], v[48:51], 0
    s_waitcnt lgkmcnt(6)
    v_mfma_f32_16x16x32_bf16 v[64:67], v[84:87], v[52:55], v[64:67]
    s_waitcnt lgkmcnt(3)
    v_mfma_f32_16x16x32_bf16 v[64:67], v[88:91], v[56:59], v[64:67]
    s_waitcnt lgkmcnt(0)
    v_mfma_f32_16x16x32_bf16 v[64:67], v[92:95], v[60:63], v[64:67]
    s_nop 7
    v_and_or_b32 v68, v64, v6, s8
    v_and_or_b32 v69, v65, v6, s9
    v_and_or_b32 v70, v66, v6, s10
    v_and_or_b32 v71, v67, v6, s11
    buffer_store_dwordx4 v[68:71], v24, s[44:47], s94 offen
    buffer_store_dwordx4 v[68:71], v24, s[44:47], s95 offen sc1
L_B_nop0:
    s_barrier
    buffer_load_dwordx4 v[128:131], v30, s[56:59], s97 offen offset:0 nt
    buffer_load_dwordx4 v[132:135], v30, s[56:59], s97 offen offset:64 nt
    buffer_load_dwordx4 v[136:139], v30, s[56:59], s97 offen offset:128 nt
    buffer_load_dwordx4 v[140:143], v30, s[56:59], s97 offen offset:192 nt
    s_add_u32 s84, s97, 0
    s_add_u32 m0, s98, 10240
    s_nop 0
    buffer_load_dwordx4 v15, s[60:63], s84 offen nt lds
    s_add_u32 s84, s97, 128
    s_add_u32 m0, s98, 26624
    s_nop 0
    buffer_load_dwordx4 v15, s[60:63], s84 offen nt lds
    s_cmp_eq_u32 s6, 7
    s_cbranch_scc0 L_B_notouch
    v_min_u32 v10, 27, v1
    v_lshlrev_b32 v10, 11, v10
    s_mul_i32 s15, s3, 57344
    s_lshl_b32 s14, s5, 7
    s_add_u32 s15, s15, s14
    s_add_u32 s15, s15, 0x160000
    buffer_load_dword v19, v10, s[44:47], s15 offen
    v_mov_b32 v10, 0
    s_lshl_b32 s15, s3, 11
    s_lshl_b32 s14, s5, 7
    s_add_u32 s15, s15, s14
    s_add_u32 s15, s15, 0x110000
    buffer_load_dword v18, v10, s[44:47], s15 offen
L_B_notouch:
    s_lshr_b32 s13, s3, 1
    s_lshl_b32 s13, s13, 15
    s_lshl_b32 s14, s6, 12
    s_add_u32 s13, s13, s14
    s_add_u32 s13, s13, 0x10000
    s_lshr_b32 s96, s3, 1
    s_lshl_b32 s96, s96, 12
    s_add_u32 s96, s96, 0x1000
    v_lshrrev_b32 v10, 5, v1
    v_lshlrev_b32 v12, 11, v10
    v_and_b32 v11, 31, v1
    v_lshlrev_b32 v13, 7, v11
    v_lshl_add_u32 v12, v11, 4, v12
    v_lshlrev_b32 v11, 3, v11
    v_lshl_add_u32 v11, v10, 2, v11
    s_mul_i32 s15, s6, 320
    v_add_u32 v11, s15, v11
    v_and_b32 v10, 7, v1
    v_mul_u32_u24 v28, 320, v10
    v_add_u32 v28, v28, v5
    v_lshlrev_b32 v21, 5, v10
    s_lshl_b32 s15, s6, 2
    v_add_u32 v20, s15, v21
    s_lshr_b32 s15, s6, 1
    s_lshl_b32 s15, s15, 6
    s_bfe_u32 s14, s6, 0x10000
    s_lshl_b32 s14, s14, 3
    s_add_u32 s15, s15, s14
    v_add_u32 v22, s15, v28
    v_lshl_add_u32 v29, v10, 14, v5
    s_mov_b32 exec_lo, 0xff00ff00
    s_mov_b32 exec_hi, 0xff00ff00
    v_mov_b32 v29, 0x80000000
    s_mov_b64 exec, -1
    s_lshr_b32 s94, s3, 1
    s_lshl_b32 s94, s94, 17
    s_lshl_b32 s14, s99, 9
    s_add_u32 s94, s94, s14
    s_lshl_b32 s14, s6, 6
    s_add_u32 s94, s94, s14
    s_add_u32 s94, s94, 0x400000
    s_lshr_b32 s95, s3, 1
    s_lshl_b32 s95, s95, 12
    s_lshl_b32 s14, s99, 7
    s_add_u32 s95, s95, s14
    s_add_u32 s95, s95, 0x8000
    v_mov_b32 v23, v7
    s_mov_b32 exec_lo, 0xffffff00
    s_mov_b32 exec_hi, 0xffffffff
    v_mov_b32 v23, 0x80000000
    s_mov_b64 exec, -1
    v_mov_b32 v16, 0x3db504f3
    v_mov_b32 v17, v16
    s_lshl_b32 s15, s6, 1
    s_cmp_ge_u32 s15, 7
    s_cselect_b32 s64, s30, s28
    s_cselect_b32 s65, s31, s29
    s_cselect_b32 s84, 7, 0
    s_mov_b32 s66, 0x700000
    s_mov_b32 s67, 0x00020000
    s_sub_u32 s15, s15, s84
    s_lshl_b32 s100, s15, 7
    s_mul_i32 s14, s5, 458752
    s_add_u32 s100, s100, s14
    s_mul_i32 s14, s3, 896
    s_add_u32 s100, s100, s14
    s_lshl_b32 s15, s6, 1
    s_add_u32 s15, s15, 0x1
    s_cmp_ge_u32 s15, 7
    s_cselect_b32 s68, s30, s28
    s_cselect_b32 s69, s31, s29
    s_cselect_b32 s84, 7, 0
    s_mov_b32 s70, 0x700000
    s_mov_b32 s71, 0x00020000
    s_sub_u32 s15, s15, s84
    s_lshl_b32 s101, s15, 7
    s_mul_i32 s14, s5, 458752
    s_add_u32 s101, s101, s14
    s_mul_i32 s14, s3, 896
    s_add_u32 s101, s101, s14
    v_mul_u32_u24 v174, 7168, v2
    v_add_u32 v174, v174, v3
    s_add_u32 s84, s97, 2048
    s_add_u32 m0, s98, 11264
    s_nop 0
    buffer_load_dwordx4 v15, s[60:63], s84 offen nt lds
    s_add_u32 s84, s97, 2176
    s_add_u32 m0, s98, 27648
    s_nop 0
    buffer_load_dwordx4 v15, s[60:63], s84 offen nt lds
    s_waitcnt vmcnt(2)
    s_barrier
    s_cmp_ge_u32 s6, 2
    s_cselect_b32 s98, 2, 0
    s_add_u32 s98, s98, s6
    s_lshl_b32 s98, s98, 14
    s_mov_b32 s12, 0
L_poll_15:
    buffer_load_dwordx4 v[32:35], v12, s[44:47], s13 offen offset:0 sc1
    buffer_load_dwordx4 v[36:39], v12, s[44:47], s13 offen offset:512 sc1
    buffer_load_dwordx4 v[40:43], v12, s[44:47], s13 offen offset:1024 sc1
    buffer_load_dwordx4 v[44:47], v12, s[44:47], s13 offen offset:1536 sc1
    s_waitcnt vmcnt(0)
    v_xor_b32 v32, s8, v32
    v_xor_b32 v33, s9, v33
    v_xor_b32 v34, s10, v34
    v_xor_b32 v35, s11, v35
    v_xor_b32 v36, s8, v36
    v_xor_b32 v37, s9, v37
    v_xor_b32 v38, s10, v38
    v_xor_b32 v39, s11, v39
    v_xor_b32 v40, s8, v40
    v_xor_b32 v41, s9, v41
    v_xor_b32 v42, s10, v42
    v_xor_b32 v43, s11, v43
    v_xor_b32 v44, s8, v44
    v_xor_b32 v45, s9, v45
    v_xor_b32 v46, s10, v46
    v_xor_b32 v47, s11, v47
    v_or3_b32 v9, v32, v33, v34
    v_or3_b32 v9, v9, v35, v36
    v_or3_b32 v9, v9, v37, v38
    v_or3_b32 v9, v9, v39, v40
    v_or3_b32 v9, v9, v41, v42
    v_or3_b32 v9, v9, v43, v44
    v_or3_b32 v9, v9, v45, v46
    v_or_b32 v9, v9, v47
    v_and_b32 v9, 0xff, v9
    v_cmp_ne_u32 vcc, 0, v9
    s_cbranch_vccz L_done_16
    s_add_u32 s12, s12, 1
    s_cmp_ge_u32 s12, 200000
    s_cbranch_scc1 L_done_16
    s_sleep 4
    s_branch L_poll_15
L_done_16:
    v_pk_add_f32 v[32:33], v[32:33], v[36:37]
    v_pk_add_f32 v[34:35], v[34:35], v[38:39]
    v_pk_add_f32 v[40:41], v[40:41], v[44:45]
    v_pk_add_f32 v[42:43], v[42:43], v[46:47]
    v_pk_add_f32 v[48:49], v[32:33], v[40:41]
    v_pk_add_f32 v[50:51], v[34:35], v[42:43]
    s_nop 1
    v_permlane32_swap_b32 v48, v50
    v_permlane32_swap_b32 v49, v51
    v_pk_add_f32 v[48:49], v[48:49], v[50:51]
    v_cvt_pk_bf16_f32 v48, v48, v49
    ds_write_b32 v11, v48 offset:4096
    s_waitcnt lgkmcnt(0)
    s_barrier
    ds_read_b128 v[32:35], v28 offset:4096
    ds_read_b128 v[36:39], v28 offset:4160
    ds_read_b128 v[40:43], v28 offset:4224
    ds_read_b128 v[44:47], v28 offset:4288
    s_sub_u32 s15, s6, 2
    s_cmp_ge_u32 s15, 5
    s_cbranch_scc1 L_B_e1
    s_add_u32 s84, s100, 0
    s_add_u32 m0, s98, 10240
    s_nop 0
    buffer_load_dwordx4 v174, s[64:67], s84 offen nt lds
    s_add_u32 s84, s101, 0
    s_add_u32 m0, s98, 18432
    s_nop 0
    buffer_load_dwordx4 v174, s[68:71], s84 offen nt lds
L_B_e1:
    s_waitcnt lgkmcnt(3)
    v_mfma_f32_16x16x32_bf16 v[64:67], v[128:131], v[32:35], 0
    s_waitcnt lgkmcnt(2)
    v_mfma_f32_16x16x32_bf16 v[64:67], v[132:135], v[36:39], v[64:67]
    s_waitcnt lgkmcnt(1)
    v_mfma_f32_16x16x32_bf16 v[64:67], v[136:139], v[40:43], v[64:67]
    s_waitcnt lgkmcnt(0)
    v_mfma_f32_16x16x32_bf16 v[64:67], v[140:143], v[44:47], v[64:67]
    s_nop 7
    v_cvt_pk_bf16_f32 v64, 0, v64
    v_cvt_pk_bf16_f32 v65, 0, v65
    v_cvt_pk_bf16_f32 v66, 0, v66
    v_cvt_pk_bf16_f32 v67, 0, v67
    v_pk_mul_f32 v[64:65], v[64:65], v[16:17]
    v_pk_mul_f32 v[66:67], v[66:67], v[16:17]
    v_cvt_pk_bf16_f32 v64, 0, v64
    v_cvt_pk_bf16_f32 v65, 0, v65
    v_cvt_pk_bf16_f32 v66, 0, v66
    v_cvt_pk_bf16_f32 v67, 0, v67
    v_max3_f32 v68, v64, v65, v66
    v_max_f32 v68, v68, v67
    v_mov_b32 v69, v68
    s_nop 1
    v_permlane16_swap_b32 v69, v68
    v_max_f32 v68, v68, v69
    v_mov_b32 v69, v68
    s_nop 1
    v_permlane32_swap_b32 v69, v68
    v_max_f32 v68, v68, v69
    ds_write_b32 v20, v68 offset:3392
    s_waitcnt lgkmcnt(0)
    s_barrier
    ds_read_b128 v[32:35], v21 offset:3392
    ds_read_b128 v[36:39], v21 offset:3408
    ds_read_b64_tr_b16 v[144:145], v31 offset:0
    ds_read_b64_tr_b16 v[146:147], v31 offset:2048
    ds_read_b64_tr_b16 v[148:149], v31 offset:4096
    ds_read_b64_tr_b16 v[150:151], v31 offset:6144
    ds_read_b64_tr_b16 v[152:153], v31 offset:8192
    ds_read_b64_tr_b16 v[154:155], v31 offset:10240
    ds_read_b64_tr_b16 v[156:157], v31 offset:12288
    ds_read_b64_tr_b16 v[158:159], v31 offset:14336
    s_waitcnt lgkmcnt(8)
    v_max3_f32 v68, v32, v33, v34
    v_max3_f32 v69, v35, v36, v37
    v_max3_f32 v68, v68, v38, v39
    v_max_f32 v72, v68, v69
    v_sub_f32 v64, v64, v72
    v_sub_f32 v65, v65, v72
    v_sub_f32 v66, v66, v72
    v_sub_f32 v67, v67, v72
    v_mul_f32 v64, s88, v64
    v_mul_f32 v65, s88, v65
    v_mul_f32 v66, s88, v66
    v_mul_f32 v67, s88, v67
    v_exp_f32 v64, v64
    v_exp_f32 v65, v65
    v_exp_f32 v66, v66
    v_exp_f32 v67, v67
    v_cvt_pk_bf16_f32 v70, v64, v65
    v_cvt_pk_bf16_f32 v71, v66, v67
    ds_write_b64 v22, v[70:71] offset:6656
    v_pk_add_f32 v[68:69], v[64:65], v[66:67]
    v_add_f32 v68, v68, v69
    v_mov_b32 v69, v68
    s_nop 1
    v_permlane16_swap_b32 v69, v68
    v_add_f32 v68, v68, v69
    v_mov_b32 v69, v68
    s_nop 1
    v_permlane32_swap_b32 v69, v68
    v_add_f32 v68, v68, v69
    ds_write_b32 v20, v68 offset:3648
    v_or_b32 v72, s8, v72
    s_waitcnt lgkmcnt(0)
    s_barrier
    s_cmp_eq_u32 s6, 7
    s_cbranch_scc0 L_B_nostat
    ds_read_b128 v[48:51], v21 offset:3648
    ds_read_b128 v[52:55], v21 offset:3664
L_B_nostat:
    ds_read_b128 v[32:35], v28 offset:6656
    ds_read_b128 v[36:39], v28 offset:6720
    ds_read_b128 v[40:43], v28 offset:6784
    ds_read_b128 v[44:47], v28 offset:6848
    s_cbranch_scc0 L_B_nostat2
    s_waitcnt lgkmcnt(4)
    v_pk_add_f32 v[48:49], v[48:49], v[50:51]
    v_pk_add_f32 v[52:53], v[52:53], v[54:55]
    v_pk_add_f32 v[48:49], v[48:49], v[52:53]
    v_add_f32 v73, v48, v49
    v_and_or_b32 v73, v73, v6, s9
    buffer_store_dwordx2 v[72:73], v23, s[44:47], s95 offen sc1
L_B_nostat2:
    s_waitcnt lgkmcnt(3)
    v_mfma_f32_16x16x32_bf16 v[64:67], v[144:147], v[32:35], 0
    s_waitcnt lgkmcnt(2)
    v_mfma_f32_16x16x32_bf16 v[64:67], v[148:151], v[36:39], v[64:67]
    s_waitcnt lgkmcnt(1)
    v_mfma_f32_16x16x32_bf16 v[64:67], v[152:155], v[40:43], v[64:67]
    s_waitcnt lgkmcnt(0)
    v_mfma_f32_16x16x32_bf16 v[64:67], v[156:159], v[44:47], v[64:67]
    s_nop 7
    v_and_or_b32 v68, v64, v6, s8
    v_and_or_b32 v69, v65, v6, s9
    v_and_or_b32 v70, v66, v6, s10
    v_and_or_b32 v71, v67, v6, s11
    buffer_store_dwordx4 v[68:71], v29, s[44:47], s94 offen sc1
    s_barrier
    s_cmp_eq_u32 s6, 7
    s_cbranch_scc1 L_B_w7
    s_cmp_ge_u32 s6, 2
    s_cbranch_scc1 L_B_e2
    s_add_u32 s84, s100, 0
    s_add_u32 m0, s98, 10240
    s_nop 0
    buffer_load_dwordx4 v174, s[64:67], s84 offen nt lds
    s_add_u32 s84, s101, 0
    s_add_u32 m0, s98, 18432
    s_nop 0
    buffer_load_dwordx4 v174, s[68:71], s84 offen nt lds
L_B_e2:
    s_add_u32 s84, s100, 57344
    s_add_u32 m0, s98, 11264
    s_nop 0
    buffer_load_dwordx4 v174, s[64:67], s84 offen nt lds
    s_add_u32 s84, s101, 57344
    s_add_u32 m0, s98, 19456
    s_nop 0
    buffer_load_dwordx4 v174, s[68:71], s84 offen nt lds
    s_add_u32 s84, s100, 114688
    s_add_u32 m0, s98, 12288
    s_nop 0
    buffer_load_dwordx4 v174, s[64:67], s84 offen nt lds
    s_add_u32 s84, s101, 114688
    s_add_u32 m0, s98, 20480
    s_nop 0
    buffer_load_dwordx4 v174, s[68:71], s84 offen nt lds
    s_add_u32 s84, s100, 172032
    s_add_u32 m0, s98, 13312
    s_nop 0
    buffer_load_dwordx4 v174, s[64:67], s84 offen nt lds
    s_add_u32 s84, s101, 172032
    s_add_u32 m0, s98, 21504
    s_nop 0
    buffer_load_dwordx4 v174, s[68:71], s84 offen nt lds
    s_add_u32 s84, s100, 229376
    s_add_u32 m0, s98, 14336
    s_nop 0
    buffer_load_dwordx4 v174, s[64:67], s84 offen nt lds
    s_add_u32 s84, s101, 229376
    s_add_u32 m0, s98, 22528
    s_nop 0
    buffer_load_dwordx4 v174, s[68:71], s84 offen nt lds
    s_add_u32 s84, s100, 286720
    s_add_u32 m0, s98, 15360
    s_nop 0
    buffer_load_dwordx4 v174, s[64:67], s84 offen nt lds
    s_add_u32 s84, s101, 286720
    s_add_u32 m0, s98, 23552
    s_nop 0
    buffer_load_dwordx4 v174, s[68:71], s84 offen nt lds
    s_add_u32 s84, s100, 344064
    s_add_u32 m0, s98, 16384
    s_nop 0
    buffer_load_dwordx4 v174, s[64:67], s84 offen nt lds
    s_add_u32 s84, s101, 344064
    s_add_u32 m0, s98, 24576
    s_nop 0
    buffer_load_dwordx4 v174, s[68:71], s84 offen nt lds
    s_add_u32 s84, s100, 401408
    s_add_u32 m0, s98, 17408
    s_nop 0
    buffer_load_dwordx4 v174, s[64:67], s84 offen nt lds
    s_add_u32 s84, s101, 401408
    s_add_u32 m0, s98, 25600
    s_nop 0
    buffer_load_dwordx4 v174, s[68:71], s84 offen nt lds
    s_cmp_eq_u32 s6, 6
    s_cbranch_scc0 L_B_nohw
    s_lshl_b32 s15, s3, 11
    s_lshl_b32 s14, s5, 7
    s_add_u32 s15, s15, s14
    s_add_u32 s15, s15, 0x70000
    v_mov_b32 v12, 0
    s_mov_b32 exec_lo, 0xfffffffe
    s_mov_b32 exec_hi, 0xffffffff
    v_mov_b32 v12, 0x80000000
    s_mov_b64 exec, -1
    v_mov_b32 v13, s7
    buffer_store_dword v13, v12, s[44:47], s15 offen sc1
L_B_nohw:
    s_add_u32 s98, s98, 10240
    v_xor_b32 v16, 0, v4
    v_add_u32 v16, s98, v16
    v_xor_b32 v17, 32, v4
    v_add_u32 v17, s98, v17
    v_xor_b32 v18, 64, v4
    v_add_u32 v18, s98, v18
    v_xor_b32 v19, 96, v4
    v_add_u32 v19, s98, v19
    s_mul_i32 s94, s3, 57344
    s_lshl_b32 s14, s6, 13
    s_add_u32 s94, s94, s14
    s_lshl_b32 s14, s5, 7
    s_add_u32 s94, s94, s14
    s_add_u32 s94, s94, 0x160000
    s_add_u32 s95, s94, 0x100000
    v_bfe_u32 v12, v1, 1, 2
    v_lshlrev_b32 v12, 11, v12
    v_and_b32 v13, 1, v1
    v_lshl_add_u32 v12, v13, 6, v12
    v_add_u32 v12, v12, v5
    s_mov_b32 exec_lo, 0xff00ff00
    s_mov_b32 exec_hi, 0xff00ff00
    v_mov_b32 v12, 0x80000000
    s_mov_b64 exec, -1
    s_mov_b32 s99, 0
    s_branch L_B_p4
L_B_p4pre:
    s_waitcnt vmcnt(8)
    ds_read_b64_tr_b16 v[128:129], v16 offset:0
    ds_read_b64_tr_b16 v[130:131], v16 offset:2048
    ds_read_b64_tr_b16 v[136:137], v17 offset:0
    ds_read_b64_tr_b16 v[138:139], v17 offset:2048
    ds_read_b64_tr_b16 v[144:145], v18 offset:0
    ds_read_b64_tr_b16 v[146:147], v18 offset:2048
    ds_read_b64_tr_b16 v[152:153], v19 offset:0
    ds_read_b64_tr_b16 v[154:155], v19 offset:2048
    ds_read_b64_tr_b16 v[160:161], v16 offset:8192
    ds_read_b64_tr_b16 v[162:163], v16 offset:10240
    ds_read_b64_tr_b16 v[168:169], v17 offset:8192
    ds_read_b64_tr_b16 v[170:171], v17 offset:10240
    ds_read_b64_tr_b16 v[176:177], v18 offset:8192
    ds_read_b64_tr_b16 v[178:179], v18 offset:10240
    ds_read_b64_tr_b16 v[184:185], v19 offset:8192
    ds_read_b64_tr_b16 v[186:187], v19 offset:10240
    s_waitcnt vmcnt(3)
    s_barrier
    s_waitcnt vmcnt(0)
    ds_read_b64_tr_b16 v[132:133], v16 offset:4096
    ds_read_b64_tr_b16 v[134:135], v16 offset:6144
    ds_read_b64_tr_b16 v[140:141], v17 offset:4096
    ds_read_b64_tr_b16 v[142:143], v17 offset:6144
    ds_read_b64_tr_b16 v[148:149], v18 offset:4096
    ds_read_b64_tr_b16 v[150:151], v18 offset:6144
    ds_read_b64_tr_b16 v[156:157], v19 offset:4096
    ds_read_b64_tr_b16 v[158:159], v19 offset:6144
    ds_read_b64_tr_b16 v[164:165], v16 offset:12288
    ds_read_b64_tr_b16 v[166:167], v16 offset:14336
    ds_read_b64_tr_b16 v[172:173], v17 offset:12288
    ds_read_b64_tr_b16 v[174:175], v17 offset:14336
    ds_read_b64_tr_b16 v[180:181], v18 offset:12288
    ds_read_b64_tr_b16 v[182:183], v18 offset:14336
    ds_read_b64_tr_b16 v[188:189], v19 offset:12288
    ds_read_b64_tr_b16 v[190:191], v19 offset:14336
    s_waitcnt lgkmcnt(0)
    s_barrier
L_B_p4:
    ds_read_b128 v[32:35], v5 offset:2816
    ds_read_b128 v[36:39], v5 offset:2880
    s_waitcnt lgkmcnt(0)
    v_mfma_f32_16x16x32_bf16 v[64:67], v[128:131], v[32:35], 0
    v_mfma_f32_16x16x32_bf16 v[64:67], v[132:135], v[36:39], v[64:67]
    v_mfma_f32_16x16x32_bf16 v[68:71], v[136:139], v[32:35], 0
    v_mfma_f32_16x16x32_bf16 v[68:71], v[140:143], v[36:39], v[68:71]
    v_mfma_f32_16x16x32_bf16 v[72:75], v[144:147], v[32:35], 0
    v_mfma_f32_16x16x32_bf16 v[72:75], v[148:151], v[36:39], v[72:75]
    v_mfma_f32_16x16x32_bf16 v[76:79], v[152:155], v[32:35], 0
    v_mfma_f32_16x16x32_bf16 v[76:79], v[156:159], v[36:39], v[76:79]
    s_mov_b32 exec_lo, 0x10001
    s_mov_b32 exec_hi, 0x10001
    v_and_or_b32 v96, v64, v6, s8
    v_and_or_b32 v97, v65, v6, s9
    v_and_or_b32 v98, v66, v6, s10
    v_and_or_b32 v99, v67, v6, s11
    s_mov_b64 exec, -1
    v_mfma_f32_16x16x32_bf16 v[80:83], v[160:163], v[32:35], 0
    v_mfma_f32_16x16x32_bf16 v[80:83], v[164:167], v[36:39], v[80:83]
    s_mov_b32 exec_lo, 0x20002
    s_mov_b32 exec_hi, 0x20002
    v_and_or_b32 v96, v68, v6, s8
    v_and_or_b32 v97, v69, v6, s9
    v_and_or_b32 v98, v70, v6, s10
    v_and_or_b32 v99, v71, v6, s11
    s_mov_b64 exec, -1
    v_mfma_f32_16x16x32_bf16 v[84:87], v[168:171], v[32:35], 0
    v_mfma_f32_16x16x32_bf16 v[84:87], v[172:175], v[36:39], v[84:87]
    s_mov_b32 exec_lo, 0x40004
    s_mov_b32 exec_hi, 0x40004
    v_and_or_b32 v96, v72, v6, s8
    v_and_or_b32 v97, v73, v6, s9
    v_and_or_b32 v98, v74, v6, s10
    v_and_or_b32 v99, v75, v6, s11
    s_mov_b64 exec, -1
    v_mfma_f32_16x16x32_bf16 v[88:91], v[176:179], v[32:35], 0
    v_mfma_f32_16x16x32_bf16 v[88:91], v[180:183], v[36:39], v[88:91]
    s_mov_b32 exec_lo, 0x80008
    s_mov_b32 exec_hi, 0x80008
    v_and_or_b32 v96, v76, v6, s8
    v_and_or_b32 v97, v77, v6, s9
    v_and_or_b32 v98, v78, v6, s10
    v_and_or_b32 v99, v79, v6, s11
    s_mov_b64 exec, -1
    v_mfma_f32_16x16x32_bf16 v[92:95], v[184:187], v[32:35], 0
    v_mfma_f32_16x16x32_bf16 v[92:95], v[188:191], v[36:39], v[92:95]
    s_mov_b32 exec_lo, 0x100010
    s_mov_b32 exec_hi, 0x100010
    v_and_or_b32 v96, v80, v6, s8
    v_and_or_b32 v97, v81, v6, s9
    v_and_or_b32 v98, v82, v6, s10
    v_and_or_b32 v99, v83, v6, s11
    s_mov_b64 exec, -1
    s_mov_b32 exec_lo, 0x200020
    s_mov_b32 exec_hi, 0x200020
    v_and_or_b32 v96, v84, v6, s8
    v_and_or_b32 v97, v85, v6, s9
    v_and_or_b32 v98, v86, v6, s10
    v_and_or_b32 v99, v87, v6, s11
    s_mov_b32 exec_lo, 0x400040
    s_mov_b32 exec_hi, 0x400040
    v_and_or_b32 v96, v88, v6, s8
    v_and_or_b32 v97, v89, v6, s9
    v_and_or_b32 v98, v90, v6, s10
    v_and_or_b32 v99, v91, v6, s11
    s_mov_b32 exec_lo, 0x800080
    s_mov_b32 exec_hi, 0x800080
    v_and_or_b32 v96, v92, v6, s8
    v_and_or_b32 v97, v93, v6, s9
    v_and_or_b32 v98, v94, v6, s10
    v_and_or_b32 v99, v95, v6, s11
    s_mov_b64 exec, -1
    s_cmp_eq_u32 s99, 0
    s_mov_b32 s99, 1
    s_cbranch_scc1 L_B_p4pre
    buffer_store_dwordx4 v[96:99], v12, s[44:47], s94 offen
    buffer_store_dwordx4 v[96:99], v12, s[44:47], s95 offen sc1
    s_branch L_fin
L_B_w7:
    s_setprio 3
    v_and_b32 v12, 15, v1
    v_lshrrev_b32 v13, 4, v1
    v_lshl_add_u32 v16, v12, 2, v13
    v_lshlrev_b32 v17, 1, v16
    s_lshl_b32 s15, s5, 7
    buffer_load_ushort v67, v17, s[72:75], s15 offen
    v_lshlrev_b32 v16, 2, v16
    v_lshlrev_b32 v18, 4, v12
    v_lshl_add_u32 v21, v5, 7, v18
    v_add_u32 v22, 8192, v21
    v_add_u32 v23, 16384, v21
    v_lshlrev_b32 v18, 7, v12
    v_and_b32 v10, 3, v12
    v_lshlrev_b32 v10, 4, v10
    v_and_b32 v11, 4, v12
    v_lshl_add_u32 v10, v11, 1, v10
    v_and_b32 v11, 1, v2
    v_lshl_add_u32 v10, v11, 6, v10
    v_lshl_add_u32 v10, v13, 1, v10
    v_add_u32 v11, 4096, v7
    v_mov_b32 v169, 0
    s_mov_b32 exec_lo, 0xfffffffe
    s_mov_b32 exec_hi, 0xffffffff
    v_mov_b32 v169, 0x80000000
    s_mov_b64 exec, -1
    v_mov_b32 v173, s7
    v_lshrrev_b32 v14, 1, v5
    v_lshrrev_b32 v173, v14, v173
    v_and_b32 v173, 0xff, v173
    s_lshr_b32 s96, s5, 1
    s_lshl_b32 s96, s96, 15
    s_bfe_u32 s14, s5, 0x10000
    s_lshl_b32 s14, s14, 8
    s_add_u32 s96, s96, s14
    s_add_u32 s96, s96, 0x80000
    s_lshl_b32 s13, s5, 13
    s_add_u32 s13, s13, 0x30000
    s_lshl_b32 s97, s3, 11
    s_add_u32 s97, s97, 0x110000
    s_lshl_b32 s94, s5, 7
    s_add_u32 s94, s94, s97
    s_add_u32 s95, s94, 0x100000
    s_lshl_b32 s100, s5, 8
    s_add_u32 s100, s100, 0xd000
    s_barrier
    buffer_load_dwordx4 v[80:83], v21, s[44:47], s96 offen offset:0 sc1
    buffer_load_dwordx4 v[84:87], v21, s[44:47], s96 offen offset:512 sc1
    buffer_load_dwordx4 v[88:91], v21, s[44:47], s96 offen offset:1024 sc1
    buffer_load_dwordx4 v[92:95], v21, s[44:47], s96 offen offset:1536 sc1
    s_mov_b32 s12, 0
    buffer_load_dwordx4 v[32:35], v7, s[44:47], s13 offen offset:0 sc1
    buffer_load_dwordx4 v[36:39], v7, s[44:47], s13 offen offset:1024 sc1
    buffer_load_dwordx4 v[40:43], v7, s[44:47], s13 offen offset:2048 sc1
    buffer_load_dwordx4 v[44:47], v7, s[44:47], s13 offen offset:3072 sc1
    buffer_load_dwordx4 v[48:51], v11, s[44:47], s13 offen offset:0 sc1
    buffer_load_dwordx4 v[52:55], v11, s[44:47], s13 offen offset:1024 sc1
    buffer_load_dwordx4 v[56:59], v11, s[44:47], s13 offen offset:2048 sc1
    buffer_load_dwordx4 v[60:63], v11, s[44:47], s13 offen offset:3072 sc1
    buffer_load_dwordx4 v[96:99], v22, s[44:47], s96 offen offset:0 sc1
    buffer_load_dwordx4 v[100:103], v22, s[44:47], s96 offen offset:512 sc1
    buffer_load_dwordx4 v[104:107], v22, s[44:47], s96 offen offset:1024 sc1
    buffer_load_dwordx4 v[108:111], v22, s[44:47], s96 offen offset:1536 sc1
    buffer_load_dwordx4 v[112:115], v23, s[44:47], s96 offen offset:0 sc1
    buffer_load_dwordx4 v[116:119], v23, s[44:47], s96 offen offset:512 sc1
    buffer_load_dwordx4 v[120:123], v23, s[44:47], s96 offen offset:1024 sc1
    buffer_load_dwordx4 v[124:127], v23, s[44:47], s96 offen offset:1536 sc1
    s_waitcnt vmcnt(16)
    v_xor_b32 v80, s8, v80
    v_xor_b32 v81, s9, v81
    v_xor_b32 v82, s10, v82
    v_xor_b32 v83, s11, v83
    v_xor_b32 v84, s8, v84
    v_xor_b32 v85, s9, v85
    v_xor_b32 v86, s10, v86
    v_xor_b32 v87, s11, v87
    v_xor_b32 v88, s8, v88
    v_xor_b32 v89, s9, v89
    v_xor_b32 v90, s10, v90
    v_xor_b32 v91, s11, v91
    v_xor_b32 v92, s8, v92
    v_xor_b32 v93, s9, v93
    v_xor_b32 v94, s10, v94
    v_xor_b32 v95, s11, v95
    v_or3_b32 v9, v80, v81, v82
    v_or3_b32 v9, v9, v83, v84
    v_or3_b32 v9, v9, v85, v86
    v_or3_b32 v9, v9, v87, v88
    v_or3_b32 v9, v9, v89, v90
    v_or3_b32 v9, v9, v91, v92
    v_or3_b32 v9, v9, v93, v94
    v_or_b32 v9, v9, v95
    v_and_b32 v9, 0xff, v9
    v_cmp_ne_u32 vcc, 0, v9
    s_cbranch_vccz L_mok_21
    s_mov_b32 s12, 0
L_poll_22:
    buffer_load_dwordx4 v[80:83], v21, s[44:47], s96 offen offset:0 sc1
    buffer_load_dwordx4 v[84:87], v21, s[44:47], s96 offen offset:512 sc1
    buffer_load_dwordx4 v[88:91], v21, s[44:47], s96 offen offset:1024 sc1
    buffer_load_dwordx4 v[92:95], v21, s[44:47], s96 offen offset:1536 sc1
    s_waitcnt vmcnt(0)
    v_xor_b32 v80, s8, v80
    v_xor_b32 v81, s9, v81
    v_xor_b32 v82, s10, v82
    v_xor_b32 v83, s11, v83
    v_xor_b32 v84, s8, v84
    v_xor_b32 v85, s9, v85
    v_xor_b32 v86, s10, v86
    v_xor_b32 v87, s11, v87
    v_xor_b32 v88, s8, v88
    v_xor_b32 v89, s9, v89
    v_xor_b32 v90, s10, v90
    v_xor_b32 v91, s11, v91
    v_xor_b32 v92, s8, v92
    v_xor_b32 v93, s9, v93
    v_xor_b32 v94, s10, v94
    v_xor_b32 v95, s11, v95
    v_or3_b32 v9, v80, v81, v82
    v_or3_b32 v9, v9, v83, v84
    v_or3_b32 v9, v9, v85, v86
    v_or3_b32 v9, v9, v87, v88
    v_or3_b32 v9, v9, v89, v90
    v_or3_b32 v9, v9, v91, v92
    v_or3_b32 v9, v9, v93, v94
    v_or_b32 v9, v9, v95
    v_and_b32 v9, 0xff, v9
    v_cmp_ne_u32 vcc, 0, v9
    s_cbranch_vccz L_done_23
    s_add_u32 s12, s12, 1
    s_cmp_ge_u32 s12, 200000
    s_cbranch_scc1 L_done_23
    s_sleep 8
    s_branch L_poll_22
L_done_23:
    s_mov_b32 s12, 0
L_mok_21:
    v_pk_add_f32 v[80:81], v[80:81], v[84:85]
    v_pk_add_f32 v[82:83], v[82:83], v[86:87]
    v_pk_add_f32 v[88:89], v[88:89], v[92:93]
    v_pk_add_f32 v[90:91], v[90:91], v[94:95]
    v_pk_add_f32 v[80:81], v[80:81], v[88:89]
    v_pk_add_f32 v[82:83], v[82:83], v[90:91]
    s_nop 1
    v_permlane32_swap_b32 v80, v82
    v_permlane32_swap_b32 v81, v83
    v_pk_add_f32 v[80:81], v[80:81], v[82:83]
    s_nop 1
    v_permlane16_swap_b32 v80, v81
    v_add_f32 v64, v80, v81
    v_cvt_pk_bf16_f32 v64, 0, v64
    v_lshlrev_b32 v67, 16, v67
    s_waitcnt vmcnt(8)
    s_branch L_chk_20
L_poll_18:
    buffer_load_dwordx4 v[32:35], v7, s[44:47], s13 offen offset:0 sc1
    buffer_load_dwordx4 v[36:39], v7, s[44:47], s13 offen offset:1024 sc1
    buffer_load_dwordx4 v[40:43], v7, s[44:47], s13 offen offset:2048 sc1
    buffer_load_dwordx4 v[44:47], v7, s[44:47], s13 offen offset:3072 sc1
    buffer_load_dwordx4 v[48:51], v11, s[44:47], s13 offen offset:0 sc1
    buffer_load_dwordx4 v[52:55], v11, s[44:47], s13 offen offset:1024 sc1
    buffer_load_dwordx4 v[56:59], v11, s[44:47], s13 offen offset:2048 sc1
    buffer_load_dwordx4 v[60:63], v11, s[44:47], s13 offen offset:3072 sc1
    s_waitcnt vmcnt(0)
L_chk_20:
    v_xor_b32 v32, s8, v32
    v_xor_b32 v33, s9, v33
    v_xor_b32 v34, s10, v34
    v_xor_b32 v35, s11, v35
    v_xor_b32 v36, s8, v36
    v_xor_b32 v37, s9, v37
    v_xor_b32 v38, s10, v38
    v_xor_b32 v39, s11, v39
    v_xor_b32 v40, s8, v40
    v_xor_b32 v41, s9, v41
    v_xor_b32 v42, s10, v42
    v_xor_b32 v43, s11, v43
    v_xor_b32 v44, s8, v44
    v_xor_b32 v45, s9, v45
    v_xor_b32 v46, s10, v46
    v_xor_b32 v47, s11, v47
    v_xor_b32 v48, s8, v48
    v_xor_b32 v49, s9, v49
    v_xor_b32 v50, s10, v50
    v_xor_b32 v51, s11, v51
    v_xor_b32 v52, s8, v52
    v_xor_b32 v53, s9, v53
    v_xor_b32 v54, s10, v54
    v_xor_b32 v55, s11, v55
    v_xor_b32 v56, s8, v56
    v_xor_b32 v57, s9, v57
    v_xor_b32 v58, s10, v58
    v_xor_b32 v59, s11, v59
    v_xor_b32 v60, s8, v60
    v_xor_b32 v61, s9, v61
    v_xor_b32 v62, s10, v62
    v_xor_b32 v63, s11, v63
    v_or3_b32 v9, v32, v33, v34
    v_or3_b32 v9, v9, v35, v36
    v_or3_b32 v9, v9, v37, v38
    v_or3_b32 v9, v9, v39, v40
    v_or3_b32 v9, v9, v41, v42
    v_or3_b32 v9, v9, v43, v44
    v_or3_b32 v9, v9, v45, v46
    v_or3_b32 v9, v9, v47, v48
    v_or3_b32 v9, v9, v49, v50
    v_or3_b32 v9, v9, v51, v52
    v_or3_b32 v9, v9, v53, v54
    v_or3_b32 v9, v9, v55, v56
    v_or3_b32 v9, v9, v57, v58
    v_or3_b32 v9, v9, v59, v60
    v_or3_b32 v9, v9, v61, v62
    v_or_b32 v9, v9, v63
    v_and_b32 v9, 0xff, v9
    v_cmp_ne_u32 vcc, 0, v9
    s_cbranch_vccz L_done_19
    s_add_u32 s12, s12, 1
    s_cmp_ge_u32 s12, 200000
    s_cbranch_scc1 L_done_19
    s_sleep 2
    s_branch L_poll_18
L_done_19:
    v_pk_add_f32 v[32:33], v[32:33], v[36:37]
    v_pk_add_f32 v[34:35], v[34:35], v[38:39]
    v_pk_add_f32 v[40:41], v[40:41], v[44:45]
    v_pk_add_f32 v[42:43], v[42:43], v[46:47]
    v_pk_add_f32 v[48:49], v[48:49], v[52:53]
    v_pk_add_f32 v[50:51], v[50:51], v[54:55]
    v_pk_add_f32 v[56:57], v[56:57], v[60:61]
    v_pk_add_f32 v[58:59], v[58:59], v[62:63]
    v_pk_add_f32 v[32:33], v[32:33], v[40:41]
    v_pk_add_f32 v[34:35], v[34:35], v[42:43]
    v_pk_add_f32 v[48:49], v[48:49], v[56:57]
    v_pk_add_f32 v[50:51], v[50:51], v[58:59]
    v_pk_add_f32 v[68:69], v[32:33], v[48:49]
    v_pk_add_f32 v[70:71], v[34:35], v[50:51]
    s_nop 1
    v_permlane32_swap_b32 v68, v70
    v_permlane32_swap_b32 v69, v71
    v_pk_add_f32 v[68:69], v[68:69], v[70:71]
    s_nop 1
    v_permlane16_swap_b32 v68, v69
    v_add_f32 v72, v68, v69
    v_cvt_pk_bf16_f32 v72, 0, v72
    v_mul_f32 v72, v72, v64
    v_cvt_pk_bf16_f32 v72, 0, v72
    v_add_f32 v72, v72, v67
    v_cvt_pk_bf16_f32 v72, 0, v72
    v_mul_f32 v78, v72, v72
    v_mov_b32 v76, v72
    s_nop 1
    v_add_f32_dpp v76, v76, v76 quad_perm:[1,0,3,2] row_mask:0xf bank_mask:0xf
    v_add_f32_dpp v78, v78, v78 quad_perm:[1,0,3,2] row_mask:0xf bank_mask:0xf
    s_nop 0
    v_add_f32_dpp v76, v76, v76 quad_perm:[2,3,0,1] row_mask:0xf bank_mask:0xf
    v_add_f32_dpp v78, v78, v78 quad_perm:[2,3,0,1] row_mask:0xf bank_mask:0xf
    s_nop 0
    v_add_f32_dpp v76, v76, v76 row_half_mirror row_mask:0xf bank_mask:0xf
    v_add_f32_dpp v78, v78, v78 row_half_mirror row_mask:0xf bank_mask:0xf
    s_nop 0
    v_add_f32_dpp v76, v76, v76 row_mirror row_mask:0xf bank_mask:0xf
    v_add_f32_dpp v78, v78, v78 row_mirror row_mask:0xf bank_mask:0xf
    v_mov_b32 v77, v76
    v_mov_b32 v79, v78
    s_nop 0
    v_permlane16_swap_b32 v77, v76
    v_permlane16_swap_b32 v79, v78
    v_add_f32 v76, v76, v77
    v_add_f32 v78, v78, v79
    v_mov_b32 v77, v76
    v_mov_b32 v79, v78
    s_nop 0
    v_permlane32_swap_b32 v77, v76
    v_permlane32_swap_b32 v79, v78
    v_add_f32 v76, v76, v77
    v_add_f32 v78, v78, v79
    v_and_b32 v80, v6, v76
    v_and_b32 v81, v6, v78
    v_sub_f32 v77, v76, v80
    v_sub_f32 v79, v78, v81
    v_and_or_b32 v80, v76, v6, s8
    v_and_or_b32 v81, v77, v6, s9
    v_and_or_b32 v82, v78, v6, s10
    v_and_or_b32 v83, v79, v6, s11
    buffer_store_dwordx4 v[80:83], v169, s[44:47], s94 offen
    buffer_load_dwordx4 v[32:35], v18, s[44:47], s97 offen sc1
    s_waitcnt vmcnt(2)
    v_xor_b32 v96, s8, v96
    v_xor_b32 v97, s9, v97
    v_xor_b32 v98, s10, v98
    v_xor_b32 v99, s11, v99
    v_xor_b32 v100, s8, v100
    v_xor_b32 v101, s9, v101
    v_xor_b32 v102, s10, v102
    v_xor_b32 v103, s11, v103
    v_xor_b32 v104, s8, v104
    v_xor_b32 v105, s9, v105
    v_xor_b32 v106, s10, v106
    v_xor_b32 v107, s11, v107
    v_xor_b32 v108, s8, v108
    v_xor_b32 v109, s9, v109
    v_xor_b32 v110, s10, v110
    v_xor_b32 v111, s11, v111
    v_xor_b32 v112, s8, v112
    v_xor_b32 v113, s9, v113
    v_xor_b32 v114, s10, v114
    v_xor_b32 v115, s11, v115
    v_xor_b32 v116, s8, v116
    v_xor_b32 v117, s9, v117
    v_xor_b32 v118, s10, v118
    v_xor_b32 v119, s11, v119
    v_xor_b32 v120, s8, v120
    v_xor_b32 v121, s9, v121
    v_xor_b32 v122, s10, v122
    v_xor_b32 v123, s11, v123
    v_xor_b32 v124, s8, v124
    v_xor_b32 v125, s9, v125
    v_xor_b32 v126, s10, v126
    v_xor_b32 v127, s11, v127
    v_or3_b32 v9, v96, v97, v98
    v_or3_b32 v9, v9, v99, v100
    v_or3_b32 v9, v9, v101, v102
    v_or3_b32 v9, v9, v103, v104
    v_or3_b32 v9, v9, v105, v106
    v_or3_b32 v9, v9, v107, v108
    v_or3_b32 v9, v9, v109, v110
    v_or3_b32 v9, v9, v111, v112
    v_or3_b32 v9, v9, v113, v114
    v_or3_b32 v9, v9, v115, v116
    v_or3_b32 v9, v9, v117, v118
    v_or3_b32 v9, v9, v119, v120
    v_or3_b32 v9, v9, v121, v122
    v_or3_b32 v9, v9, v123, v124
    v_or3_b32 v9, v9, v125, v126
    v_or_b32 v9, v9, v127
    v_and_b32 v9, 0xff, v9
    v_cmp_ne_u32 vcc, 0, v9
    s_cbranch_vccz L_mok_25
    s_mov_b32 s12, 0
L_poll_26:
    buffer_load_dwordx4 v[96:99], v22, s[44:47], s96 offen offset:0 sc1
    buffer_load_dwordx4 v[100:103], v22, s[44:47], s96 offen offset:512 sc1
    buffer_load_dwordx4 v[104:107], v22, s[44:47], s96 offen offset:1024 sc1
    buffer_load_dwordx4 v[108:111], v22, s[44:47], s96 offen offset:1536 sc1
    buffer_load_dwordx4 v[112:115], v23, s[44:47], s96 offen offset:0 sc1
    buffer_load_dwordx4 v[116:119], v23, s[44:47], s96 offen offset:512 sc1
    buffer_load_dwordx4 v[120:123], v23, s[44:47], s96 offen offset:1024 sc1
    buffer_load_dwordx4 v[124:127], v23, s[44:47], s96 offen offset:1536 sc1
    s_waitcnt vmcnt(0)
    v_xor_b32 v96, s8, v96
    v_xor_b32 v97, s9, v97
    v_xor_b32 v98, s10, v98
    v_xor_b32 v99, s11, v99
    v_xor_b32 v100, s8, v100
    v_xor_b32 v101, s9, v101
    v_xor_b32 v102, s10, v102
    v_xor_b32 v103, s11, v103
    v_xor_b32 v104, s8, v104
    v_xor_b32 v105, s9, v105
    v_xor_b32 v106, s10, v106
    v_xor_b32 v107, s11, v107
    v_xor_b32 v108, s8, v108
    v_xor_b32 v109, s9, v109
    v_xor_b32 v110, s10, v110
    v_xor_b32 v111, s11, v111
    v_xor_b32 v112, s8, v112
    v_xor_b32 v113, s9, v113
    v_xor_b32 v114, s10, v114
    v_xor_b32 v115, s11, v115
    v_xor_b32 v116, s8, v116
    v_xor_b32 v117, s9, v117
    v_xor_b32 v118, s10, v118
    v_xor_b32 v119, s11, v119
    v_xor_b32 v120, s8, v120
    v_xor_b32 v121, s9, v121
    v_xor_b32 v122, s10, v122
    v_xor_b32 v123, s11, v123
    v_xor_b32 v124, s8, v124
    v_xor_b32 v125, s9, v125
    v_xor_b32 v126, s10, v126
    v_xor_b32 v127, s11, v127
    v_or3_b32 v9, v96, v97, v98
    v_or3_b32 v9, v9, v99, v100
    v_or3_b32 v9, v9, v101, v102
    v_or3_b32 v9, v9, v103, v104
    v_or3_b32 v9, v9, v105, v106
    v_or3_b32 v9, v9, v107, v108
    v_or3_b32 v9, v9, v109, v110
    v_or3_b32 v9, v9, v111, v112
    v_or3_b32 v9, v9, v113, v114
    v_or3_b32 v9, v9, v115, v116
    v_or3_b32 v9, v9, v117, v118
    v_or3_b32 v9, v9, v119, v120
    v_or3_b32 v9, v9, v121, v122
    v_or3_b32 v9, v9, v123, v124
    v_or3_b32 v9, v9, v125, v126
    v_or_b32 v9, v9, v127
    v_and_b32 v9, 0xff, v9
    v_cmp_ne_u32 vcc, 0, v9
    s_cbranch_vccz L_done_27
    s_add_u32 s12, s12, 1
    s_cmp_ge_u32 s12, 200000
    s_cbranch_scc1 L_done_27
    s_sleep 2
    s_branch L_poll_26
L_done_27:
L_mok_25:
    s_mov_b32 s12, 0
    v_pk_add_f32 v[96:97], v[96:97], v[100:101]
    v_pk_add_f32 v[98:99], v[98:99], v[102:103]
    v_pk_add_f32 v[104:105], v[104:105], v[108:109]
    v_pk_add_f32 v[106:107], v[106:107], v[110:111]
    v_pk_add_f32 v[96:97], v[96:97], v[104:105]
    v_pk_add_f32 v[98:99], v[98:99], v[106:107]
    s_nop 1
    v_permlane32_swap_b32 v96, v98
    v_permlane32_swap_b32 v97, v99
    v_pk_add_f32 v[96:97], v[96:97], v[98:99]
    s_nop 1
    v_permlane16_swap_b32 v96, v97
    v_add_f32 v65, v96, v97
    v_cvt_pk_bf16_f32 v65, 0, v65
    v_pk_add_f32 v[112:113], v[112:113], v[116:117]
    v_pk_add_f32 v[114:115], v[114:115], v[118:119]
    v_pk_add_f32 v[120:121], v[120:121], v[124:125]
    v_pk_add_f32 v[122:123], v[122:123], v[126:127]
    v_pk_add_f32 v[112:113], v[112:113], v[120:121]
    v_pk_add_f32 v[114:115], v[114:115], v[122:123]
    s_nop 1
    v_permlane32_swap_b32 v112, v114
    v_permlane32_swap_b32 v113, v115
    v_pk_add_f32 v[112:113], v[112:113], v[114:115]
    s_nop 1
    v_permlane16_swap_b32 v112, v113
    v_add_f32 v66, v112, v113
    v_cvt_pk_bf16_f32 v66, 0, v66
    v_add_f32 v66, 1.0, v66
    v_cvt_pk_bf16_f32 v66, 0, v66
    s_branch L_xck_32
L_x_29:
    buffer_load_dwordx4 v[32:35], v18, s[44:47], s97 offen sc1
L_xck_32:
    s_waitcnt vmcnt(0)
    v_xor_b32 v32, s8, v32
    v_xor_b32 v33, s9, v33
    v_xor_b32 v34, s10, v34
    v_xor_b32 v35, s11, v35
    v_or3_b32 v9, v32, v33, v34
    v_or_b32 v9, v9, v35
    v_and_b32 v9, 0xff, v9
    v_cmp_ne_u32 vcc, 0, v9
    s_cbranch_vccz L_xd_30
    s_add_u32 s12, s12, 1
    s_cmp_eq_u32 s12, 24
    s_cbranch_scc0 L_xng_31
    buffer_store_dwordx4 v[80:83], v169, s[44:47], s95 offen sc1
L_xng_31:
    s_cmp_eq_u32 s12, 400
    s_cselect_b32 s14, 0x100000, 0
    s_add_u32 s97, s97, s14
    s_cmp_ge_u32 s12, 200000
    s_cbranch_scc1 L_xd_30
    s_sleep 1
    s_branch L_x_29
L_xd_30:
    v_add_f32 v40, v32, v33
    v_add_f32 v42, v34, v35
    s_nop 0
    v_add_f32_dpp v40, v40, v40 quad_perm:[1,0,3,2] row_mask:0xf bank_mask:0xf
    v_add_f32_dpp v42, v42, v42 quad_perm:[1,0,3,2] row_mask:0xf bank_mask:0xf
    s_nop 0
    v_add_f32_dpp v40, v40, v40 quad_perm:[2,3,0,1] row_mask:0xf bank_mask:0xf
    v_add_f32_dpp v42, v42, v42 quad_perm:[2,3,0,1] row_mask:0xf bank_mask:0xf
    s_nop 0
    v_add_f32_dpp v40, v40, v40 row_half_mirror row_mask:0xf bank_mask:0xf
    v_add_f32_dpp v42, v42, v42 row_half_mirror row_mask:0xf bank_mask:0xf
    s_nop 0
    v_add_f32_dpp v40, v40, v40 row_mirror row_mask:0xf bank_mask:0xf
    v_add_f32_dpp v42, v42, v42 row_mirror row_mask:0xf bank_mask:0xf
    v_mul_f32 v40, 0x3a800000, v40
    v_mul_f32 v42, 0x3a800000, v42
    v_fma_f32 v42, -v40, v40, v42
    v_max_f32 v42, 0, v42
    v_cvt_pk_bf16_f32 v40, 0, v40
    v_sub_f32 v36, v72, v40
    v_cvt_pk_bf16_f32 v42, 0, v42
    v_add_f32 v42, 0x3727c5ac, v42
    v_cvt_pk_bf16_f32 v42, 0, v42
    v_sqrt_f32 v42, v42
    s_nop 0
    v_cvt_pk_bf16_f32 v42, 0, v42
    v_rcp_f32 v43, v42
    v_cvt_pk_bf16_f32 v36, 0, v36
    v_mul_f32 v36, v36, v43
    v_cvt_pk_bf16_f32 v36, 0, v36
    v_mul_f32 v36, v36, v66
    v_cvt_pk_bf16_f32 v36, 0, v36
    v_add_f32 v36, v36, v65
    v_cvt_pk_bf16_f32 v36, v36, v36
    ds_write_b16 v10, v36 offset:2816
    s_waitcnt lgkmcnt(0)
    s_barrier
    buffer_store_dwordx4 v[80:83], v169, s[44:47], s95 offen sc1
    s_lshr_b32 s15, s5, 1
    s_cmp_eq_u32 s15, s3
    s_cbranch_scc0 L_B_noxr
    v_or_b32 v73, v72, v173
    buffer_store_dword v73, v16, s[44:47], s100 offen sc1
L_B_noxr:
    v_and_b32 v11, 3, v1
    s_cmp_ge_u32 s5, 8
    s_cbranch_scc1 L_fin
    s_mov_b32 s80, s38
    s_mov_b32 s81, s39
    s_mov_b32 s82, 0x800
    s_mov_b32 s83, 0x00020000
    v_lshlrev_b32 v12, 4, v11
    v_lshrrev_b32 v13, 2, v5
    v_add_u32 v172, v13, v12
    v_lshrrev_b32 v170, 1, v172
    s_mov_b32 exec_lo, 0xfff0fff0
    s_mov_b32 exec_hi, 0xfff0fff0
    v_mov_b32 v170, 0x80000000
    s_mov_b64 exec, -1
    v_lshrrev_b32 v13, 2, v1
    v_lshl_add_u32 v17, v13, 7, v12
    s_lshl_b32 s96, s3, 9
    s_lshl_b32 s14, s5, 6
    s_add_u32 s96, s96, s14
    s_add_u32 s96, s96, 0xd000
    s_mov_b32 s12, 0
L_pd_33:
    buffer_load_dword v168, v172, s[44:47], s96 offen sc1
    s_waitcnt vmcnt(0)
    v_xor_b32 v168, v173, v168
    v_and_b32 v9, 0xffff, v168
    v_cmp_ne_u32 vcc, 0, v9
    s_cbranch_vccz L_pdd_34
    s_add_u32 s12, s12, 1
    s_cmp_ge_u32 s12, 200000
    s_cbranch_scc1 L_pdd_34
    s_sleep 1
    s_branch L_pd_33
L_pdd_34:
    s_lshl_b32 s96, s3, 15
    s_lshl_b32 s14, s5, 6
    s_add_u32 s96, s96, s14
    s_add_u32 s96, s96, 0x86000
    s_mov_b32 s12, 0
L_poll_35:
    buffer_load_dwordx4 v[32:35], v27, s[44:47], s96 offen sc1
    s_waitcnt vmcnt(0)
    v_xor_b32 v32, s8, v32
    v_xor_b32 v33, s9, v33
    v_xor_b32 v34, s10, v34
    v_xor_b32 v35, s11, v35
    v_or3_b32 v9, v32, v33, v34
    v_or_b32 v9, v9, v35
    v_and_b32 v9, 0xff, v9
    v_cmp_ne_u32 vcc, 0, v9
    s_cbranch_vccz L_done_36
    s_add_u32 s12, s12, 1
    s_cmp_ge_u32 s12, 200000
    s_cbranch_scc1 L_done_36
    s_sleep 2
    s_branch L_poll_35
L_done_36:
    v_permlane32_swap_b32 v32, v34
    v_permlane32_swap_b32 v33, v35
    v_pk_add_f32 v[32:33], v[32:33], v[34:35]
    s_nop 1
    v_permlane16_swap_b32 v32, v33
    v_add_f32 v163, v32, v33
    s_nop 1
    v_add_f32_dpp v163, v163, v163 row_ror:8 row_mask:0xf bank_mask:0xf
    s_nop 1
    v_add_f32_dpp v163, v163, v163 row_ror:4 row_mask:0xf bank_mask:0xf
    v_cvt_pk_bf16_f32 v163, 0, v163
    s_lshl_b32 s100, s3, 8
    s_lshl_b32 s14, s5, 5
    s_add_u32 s100, s100, s14
    s_lshl_b32 s13, s3, 14
    s_lshl_b32 s14, s5, 11
    s_add_u32 s13, s13, s14
    s_add_u32 s13, s13, 0x50000
    s_mov_b32 s12, 0
L_poll_38:
    buffer_load_dwordx4 v[48:51], v17, s[44:47], s13 offen sc1
    s_waitcnt vmcnt(0)
    v_xor_b32 v48, s8, v48
    v_xor_b32 v49, s9, v49
    v_xor_b32 v50, s10, v50
    v_xor_b32 v51, s11, v51
    v_or3_b32 v9, v48, v49, v50
    v_or_b32 v9, v9, v51
    v_and_b32 v9, 0xff, v9
    v_cmp_ne_u32 vcc, 0, v9
    s_cbranch_vccz L_done_39
    s_add_u32 s12, s12, 1
    s_cmp_ge_u32 s12, 200000
    s_cbranch_scc1 L_done_39
    s_sleep 1
    s_branch L_poll_38
L_done_39:
    v_permlane32_swap_b32 v48, v50
    v_permlane32_swap_b32 v49, v51
    v_pk_add_f32 v[48:49], v[48:49], v[50:51]
    s_nop 1
    v_permlane16_swap_b32 v48, v49
    v_add_f32 v52, v48, v49
    s_nop 1
    v_add_f32_dpp v52, v52, v52 row_ror:8 row_mask:0xf bank_mask:0xf
    s_nop 1
    v_add_f32_dpp v52, v52, v52 row_ror:4 row_mask:0xf bank_mask:0xf
    v_cvt_pk_bf16_f32 v52, 0, v52
    v_mul_f32 v52, v52, v163
    v_cvt_pk_bf16_f32 v52, 0, v52
    v_add_f32 v52, v52, v168
    v_cvt_pk_bf16_f32 v52, v52, v52
    buffer_store_short v52, v170, s[80:83], s100 offen
    s_cmp_eq_u32 s2, 128
    s_cbranch_scc0 L_fin
    v_mov_b32 v12, s7
    buffer_store_dword v12, v169, s[44:47], 0 offen sc1
L_fin:
L_end:
    s_endpgm
.section .rodata,"a"
.p2align 6
.amdhsa_kernel adaLN_cond__sliding_block_cached__swiglu_ffn__decode_kernel
  .amdhsa_next_free_vgpr 256
  .amdhsa_next_free_sgpr 102
  .amdhsa_accum_offset 256
  .amdhsa_group_segment_fixed_size 0
  .amdhsa_kernarg_size 112
  .amdhsa_user_sgpr_count 2
  .amdhsa_user_sgpr_kernarg_segment_ptr 1
  .amdhsa_system_sgpr_workgroup_id_x 1
  .amdhsa_float_denorm_mode_32 3
.end_amdhsa_kernel
```
